```python
import torch

def _softmax(x, axis=-1):
    return torch.softmax(x, dim=axis)
def _gelu(x):
    return torch.nn.functional.gelu(x, approximate="tanh")
def _silu(x):
    return torch.nn.functional.silu(x)
def _sigmoid(x):
    return torch.sigmoid(x)
def _layernorm(x, axis=-1, eps=1e-5):
    m = x.mean(dim=axis, keepdim=True)
    v = x.var(dim=axis, keepdim=True, unbiased=False)
    return (x - m) / torch.sqrt(v + eps)
def _scatter_add(tgt, idx, src, axis=0):
    return tgt.clone().index_add_(axis, idx, src)
def _segment_sum(src, seg, n):
    out = torch.zeros((n,) + src.shape[1:], dtype=src.dtype)
    return out.index_add_(0, seg, src)
def _pad(x, pw):
    flat = tuple(v for pair in reversed(pw) for v in pair)
    return torch.nn.functional.pad(x, flat)

kernel_name = 'gated_mix__grouped_kv_mqa__sliding_block__prompt'

def setup_inputs():

    _w = (lambda a: (lambda t: t.to(torch.bfloat16) if t.is_floating_point() else t)(torch.as_tensor(a)))
    def _A_setup():
        B, S, D, H = 1, 2048, 512, 32
        Dh = D // H
        return {
            "x": _w((lambda *s: torch.randn(*s, dtype=torch.bfloat16) * 0.05)(B, S, D)),
            "wq": _w((lambda *s: torch.randn(*s, dtype=torch.bfloat16) * 1.6)(D, H * Dh)),
            "wk": _w((lambda *s: torch.randn(*s, dtype=torch.bfloat16) * 1.6)(D, Dh)),
            "wv": _w((lambda *s: torch.randn(*s, dtype=torch.bfloat16) * 0.2)(D, Dh)),
            "wo": _w((lambda *s: torch.randn(*s, dtype=torch.bfloat16) * 0.2)(H * Dh, D)),
        }
    _A_in = _A_setup()

    def _B_setup():
        B, S, D = 1, 2048, 512
        return {
            "x": _w((lambda *s: torch.randn(*s, dtype=torch.bfloat16) * 0.05)(B, S, D)),
            "wqkv": _w((lambda *s: torch.randn(*s, dtype=torch.bfloat16) * 1.6)(D, 3 * D)),
            "wo": _w((lambda *s: torch.randn(*s, dtype=torch.bfloat16) * 0.05)(D, D)),
        }
    _B_in = _B_setup()

    return {
        "A_x": _A_in["x"],
        "A_wq": _A_in["wq"],
        "A_wk": _A_in["wk"],
        "A_wv": _A_in["wv"],
        "A_wo": _A_in["wo"],
        "B_x": _B_in["x"],
        "B_wqkv": _B_in["wqkv"],
        "B_wo": _B_in["wo"],
        "gate_w": _w((lambda *s: torch.randn(*s, dtype=torch.bfloat16) * 0.05)(512) * 16.0),
    }

def reference(A_x, A_wq, A_wk, A_wv, A_wo, B_x, B_wqkv, B_wo, gate_w):
    def _A_ref(x, wq, wk, wv, wo):
        B, S, D = x.shape
        H = 32
        Dh = D // H
        q = (lambda x, *d: x.permute(*d))((x @ wq).reshape(B, S, H, Dh), 0, 2, 1, 3)
        k = x @ wk
        v = x @ wv
        scores = torch.einsum("bhqd,bkd->bhqk", q, k) * (Dh ** -0.5)
        p = _softmax(scores, axis=-1)
        o = torch.einsum("bhqk,bkd->bhqd", p, v)
        return (lambda x, *d: x.permute(*d))(o, 0, 2, 1, 3).reshape(B, S, H * Dh) @ wo

    def _B_ref(x, wqkv, wo):
        B, S, D = x.shape
        H = 32; Dh = D // H; W = 256
        qkv = (lambda x, *d: x.permute(*d))((x @ wqkv).reshape(B, S, 3, H, Dh), 2, 0, 3, 1, 4)
        q, k, v = qkv[0], qkv[1], qkv[2]
        scores = torch.einsum("bhqd,bhkd->bhqk", q, k) * (Dh ** -0.5)
        idx = torch.arange(S)
        mask = (idx[:, None] - idx[None, :] >= 0) & (idx[:, None] - idx[None, :] < W)
        scores = torch.where(mask[None, None], scores, -1e9)
        p = _softmax(scores, axis=-1)
        o = torch.einsum("bhqk,bhkd->bhqd", p, v)
        return (lambda x, *d: x.permute(*d))(o, 0, 2, 1, 3).reshape(B, S, D) @ wo

    x = A_x
    g = _sigmoid((x * gate_w).sum(-1, keepdims=True))
    a = _A_ref(x, A_wq, A_wk, A_wv, A_wo)
    b = _B_ref(x, B_wqkv, B_wo)
    return g * a + (1 - g) * b
```

```asm
; @launch grid=(256,1,1) block=(768,1,1) lds=163840
.amdgcn_target "amdgcn-amd-amdhsa--gfx950"
.text
.globl gated_mix__grouped_kv_mqa__sliding_block__prompt_kernel
.p2align 8
.type gated_mix__grouped_kv_mqa__sliding_block__prompt_kernel,@function
gated_mix__grouped_kv_mqa__sliding_block__prompt_kernel:
    s_cmp_ge_u32 s2, 256
    s_cbranch_scc1 L_END
    s_load_dwordx16 s[4:19], s[0:1], 0
    s_load_dwordx8 s[20:27], s[0:1], 64
    v_lshrrev_b32 v1, 6, v0
    v_and_b32 v0, 63, v0
    v_readfirstlane_b32 s68, v1
    s_add_u32 s72, s2, 1
    s_and_b32 s72, s72, 7
    s_lshr_b32 s73, s2, 3
    s_and_b32 s74, s73, 3
    s_lshl_b32 s69, s72, 2
    s_or_b32 s69, s69, s74
    s_lshr_b32 s70, s73, 2
    s_mov_b32 s86, 0xffff
    s_mov_b32 s87, 0xffff
    v_lshlrev_b32 v2, 3, v0
    v_add_u32 v2, 163072, v2
    v_mov_b32 v4, 0
    v_mov_b32 v5, 0
    ds_write_b64 v2, v[4:5]
    s_waitcnt lgkmcnt(0)
    s_barrier
    s_mov_b32 s28, s4
    s_mov_b32 s29, s5
    s_mov_b32 s30, 0x200000
    s_mov_b32 s31, 0x20000
    s_mov_b32 s60, s26
    s_mov_b32 s61, s27
    s_mov_b32 s62, 0x10000000
    s_mov_b32 s63, 0x20000
    s_cmp_lt_u32 s68, 8
    s_cbranch_scc1 L_A
    s_setprio 3
    s_sub_u32 s85, s68, 8
    s_cmp_eq_u32 s68, 11
    s_cbranch_scc0 L_B_NCP
    s_getpc_b64 s[72:73]
L_B_PC:
    s_lshr_b32 s74, s2, 3
    s_mul_i32 s74, s74, (L_CODE_END-L_B_PC+4095)/4096*128
    s_add_u32 s72, s72, s74
    s_addc_u32 s73, s73, 0
    v_lshlrev_b32 v2, 7, v0
    v_mov_b32 v3, s73
    v_add_co_u32 v2, vcc, s72, v2
    s_nop 1
    v_addc_co_u32 v3, vcc, 0, v3, vcc
    s_lshl_b64 exec, 1, (L_CODE_END-L_B_PC+4095)/4096
    s_sub_u32 exec_lo, exec_lo, 1
    global_load_dword v63, v[2:3], off
    s_mov_b64 exec, -1
L_B_NCP:
    v_lshrrev_b32 v17, 3, v0
    v_lshlrev_b32 v17, 10, v17
    v_lshrrev_b32 v2, 4, v0
    v_and_b32 v3, 7, v0
    v_xor_b32 v2, v2, v3
    v_lshl_add_u32 v17, v2, 4, v17
    v_xor_b32 v18, 64, v17
    s_and_b32 s83, s69, 3
    s_lshl_b32 s83, s83, 1
    s_add_u32 s83, s83, s70
    s_lshl_b32 s79, s69, 16
    s_lshl_b32 s78, s85, 13
    s_and_b32 s73, s83, 7
    s_lshl_b32 s73, s73, 7
    s_add_u32 s73, s73, s79
    s_lshl_b32 s74, s85, 14
    s_add_u32 s73, s73, s74
    s_lshl_b32 s74, s85, 11
    s_add_u32 m0, s74, 65536
    s_nop 0
    buffer_load_dwordx4 v17, s[28:31], s73 offen lds
    s_add_u32 m0, s74, 66560
    s_add_u32 s73, s73, 8192
    buffer_load_dwordx4 v18, s[28:31], s73 offen lds
    v_mov_b32 v1, 131072
    v_lshlrev_b32 v160, 4, v0
    v_lshlrev_b32 v163, 7, v0
    v_lshrrev_b32 v161, 5, v0
    v_lshlrev_b32 v161, 8, v161
    v_and_b32 v2, 15, v0
    v_lshl_add_u32 v161, v2, 4, v161
    s_mov_b32 s44, s12
    s_mov_b32 s45, s13
    s_mov_b32 s46, 0x80000
    s_mov_b32 s47, 0x20000
    s_mov_b32 s48, s18
    s_mov_b32 s49, s19
    s_mov_b32 s50, 0x80000
    s_mov_b32 s51, 0x20000
    v_and_b32 v4, 31, v0
    v_lshrrev_b32 v5, 5, v0
    v_lshlrev_b32 v5, 2, v5
    v_sub_u32 v4, v4, v5
    s_mov_b32 s72, 0xce6e6b28
    v_subrev_u32 v5, 0, v4
    v_ashrrev_i32 v5, 31, v5
    v_and_b32 v144, s72, v5
    v_xor_b32 v128, s72, v144
    v_subrev_u32 v5, 1, v4
    v_ashrrev_i32 v5, 31, v5
    v_and_b32 v145, s72, v5
    v_xor_b32 v129, s72, v145
    v_subrev_u32 v5, 2, v4
    v_ashrrev_i32 v5, 31, v5
    v_and_b32 v146, s72, v5
    v_xor_b32 v130, s72, v146
    v_subrev_u32 v5, 3, v4
    v_ashrrev_i32 v5, 31, v5
    v_and_b32 v147, s72, v5
    v_xor_b32 v131, s72, v147
    v_subrev_u32 v5, 8, v4
    v_ashrrev_i32 v5, 31, v5
    v_and_b32 v148, s72, v5
    v_xor_b32 v132, s72, v148
    v_subrev_u32 v5, 9, v4
    v_ashrrev_i32 v5, 31, v5
    v_and_b32 v149, s72, v5
    v_xor_b32 v133, s72, v149
    v_subrev_u32 v5, 10, v4
    v_ashrrev_i32 v5, 31, v5
    v_and_b32 v150, s72, v5
    v_xor_b32 v134, s72, v150
    v_subrev_u32 v5, 11, v4
    v_ashrrev_i32 v5, 31, v5
    v_and_b32 v151, s72, v5
    v_xor_b32 v135, s72, v151
    v_subrev_u32 v5, 16, v4
    v_ashrrev_i32 v5, 31, v5
    v_and_b32 v152, s72, v5
    v_xor_b32 v136, s72, v152
    v_subrev_u32 v5, 17, v4
    v_ashrrev_i32 v5, 31, v5
    v_and_b32 v153, s72, v5
    v_xor_b32 v137, s72, v153
    v_subrev_u32 v5, 18, v4
    v_ashrrev_i32 v5, 31, v5
    v_and_b32 v154, s72, v5
    v_xor_b32 v138, s72, v154
    v_subrev_u32 v5, 19, v4
    v_ashrrev_i32 v5, 31, v5
    v_and_b32 v155, s72, v5
    v_xor_b32 v139, s72, v155
    v_subrev_u32 v5, 24, v4
    v_ashrrev_i32 v5, 31, v5
    v_and_b32 v156, s72, v5
    v_xor_b32 v140, s72, v156
    v_subrev_u32 v5, 25, v4
    v_ashrrev_i32 v5, 31, v5
    v_and_b32 v157, s72, v5
    v_xor_b32 v141, s72, v157
    v_subrev_u32 v5, 26, v4
    v_ashrrev_i32 v5, 31, v5
    v_and_b32 v158, s72, v5
    v_xor_b32 v142, s72, v158
    v_subrev_u32 v5, 27, v4
    v_ashrrev_i32 v5, 31, v5
    v_and_b32 v159, s72, v5
    v_xor_b32 v143, s72, v159
    v_and_b32 v2, 27, v0
    v_cmp_eq_u32 vcc, 16, v2
    v_mov_b32 v2, 0x3f803f80
    s_nop 0
    v_cndmask_b32 v36, 0, v2, vcc
    v_mov_b32 v37, v36
    v_mov_b32 v38, v36
    v_mov_b32 v39, v36
    v_mov_b32 v40, v36
    v_mov_b32 v41, v36
    v_mov_b32 v42, v36
    v_mov_b32 v43, v36
    v_mov_b32 v44, v36
    v_mov_b32 v45, v36
    v_mov_b32 v46, v36
    v_mov_b32 v47, v36
    v_mov_b32 v48, v36
    v_mov_b32 v49, v36
    v_mov_b32 v50, v36
    v_mov_b32 v51, v36
    v_mov_b32 v52, v36
    v_mov_b32 v53, v36
    v_mov_b32 v54, v36
    v_mov_b32 v55, v36
    v_mov_b32 v56, v36
    v_mov_b32 v57, v36
    v_mov_b32 v58, v36
    v_mov_b32 v59, v36
    v_mov_b32 v60, 0xdddddddd
    v_mov_b32 v96, 0
    v_mov_b32 v97, 0
    v_mov_b32 v98, 0
    v_mov_b32 v99, 0
    v_mov_b32 v100, 0
    v_mov_b32 v101, 0
    v_mov_b32 v102, 0
    v_mov_b32 v103, 0
    v_mov_b32 v104, 0
    v_mov_b32 v105, 0
    v_mov_b32 v106, 0
    v_mov_b32 v107, 0
    v_mov_b32 v108, 0
    v_mov_b32 v109, 0
    v_mov_b32 v110, 0
    v_mov_b32 v111, 0
    v_mov_b32 v112, 0
    v_mov_b32 v113, 0
    v_mov_b32 v114, 0
    v_mov_b32 v115, 0
    v_mov_b32 v116, 0
    v_mov_b32 v117, 0
    v_mov_b32 v118, 0
    v_mov_b32 v119, 0
    v_mov_b32 v120, 0
    v_mov_b32 v121, 0
    v_mov_b32 v122, 0
    v_mov_b32 v123, 0
    v_mov_b32 v124, 0
    v_mov_b32 v125, 0
    v_mov_b32 v126, 0
    v_mov_b32 v127, 0
    v_min_u32 v2, 4, v0
    s_sub_i32 s72, s69, 4
    v_add_u32 v2, s72, v2
    v_max_i32 v2, 0, v2
    s_lshl_b32 s72, s70, 5
    v_add_u32 v2, s72, v2
    v_lshlrev_b32 v2, 7, v2
    v_add_u32 v162, 0x4008, v2
    v_and_b32 v2, 7, v0
    v_lshlrev_b32 v2, 5, v2
    v_add_u32 v2, s69, v2
    v_lshlrev_b32 v2, 7, v2
    v_add_u32 v166, 0x4010, v2
    s_lshr_b32 s81, s85, 1
    s_and_b32 s82, s85, 1
    s_lshl_b32 s74, s70, 7
    v_lshrrev_b32 v2, 3, v0
    v_lshlrev_b32 v10, 10, v2
    v_bfe_u32 v2, v0, 4, 1
    v_lshlrev_b32 v2, 2, v2
    v_and_b32 v3, 7, v0
    v_xor_b32 v2, v2, v3
    v_lshl_add_u32 v10, v2, 4, v10
    v_add_u32 v10, s74, v10
    s_lshl_b32 s73, s81, 2
    v_lshrrev_b32 v2, 5, v0
    v_lshlrev_b32 v2, 2, v2
    v_bfe_u32 v3, v0, 2, 2
    v_add_u32 v2, v2, v3
    v_lshlrev_b32 v11, 7, v2
    v_bfe_u32 v2, v0, 4, 1
    v_lshlrev_b32 v2, 1, v2
    v_bfe_u32 v3, v0, 1, 1
    v_add3_u32 v2, v2, v3, s73
    v_bfe_u32 v3, v0, 3, 1
    v_lshlrev_b32 v3, 2, v3
    v_xor_b32 v2, v2, v3
    v_lshl_add_u32 v11, v2, 4, v11
    v_and_b32 v2, 1, v0
    v_lshl_add_u32 v11, v2, 3, v11
    s_lshl_b32 s73, s81, 15
    s_add_u32 s73, s73, 0
    v_add_u32 v11, s73, v11
    v_xor_b32 v9, 64, v11
    s_lshl_b32 s66, s69, 1
    s_add_u32 s66, s66, s82
    s_lshl_b32 s66, s66, 15
    s_lshl_b32 s72, s81, 14
    s_add_u32 s67, s66, s72
    s_add_u32 s67, s67, 0x840000
    s_lshl_b32 s72, s70, 7
    s_add_u32 s66, s66, s72
    s_lshl_b32 s72, s81, 6
    s_add_u32 s66, s66, s72
    v_and_b32 v8, 31, v0
    v_lshlrev_b32 v167, 10, v8
    v_lshrrev_b32 v3, 5, v0
    v_lshl_add_u32 v167, v3, 4, v167
    v_lshlrev_b32 v8, 2, v8
    s_mov_b32 s56, s22
    s_mov_b32 s57, s23
    s_mov_b32 s58, 0x200000
    s_mov_b32 s59, 0x20000
    s_lshl_b32 s72, s85, 12
    s_add_u32 s72, s72, 65536
    v_add_u32 v164, s72, v160
    v_xor_b32 v165, 0x2000, v164
    s_mov_b32 s64, 0
    s_waitcnt vmcnt(0)
    s_lshl_b32 s72, s85, 2
    s_add_u32 s72, s72, 163408
    v_mov_b32 v2, s72
    v_mov_b32 v3, 1
    s_mov_b64 exec, 1
    ds_write_b32 v2, v3
    s_mov_b64 exec, -1
    s_cmp_eq_u32 s85, 0
    s_cselect_b32 s40, s6, s16
    s_cselect_b32 s41, s7, s17
    s_mov_b32 s42, 1572864
    s_cselect_b32 s42, 524288, s42
    s_mov_b32 s43, 0x20000
    s_movk_i32 s75, 3072
    s_cselect_b32 s75, 0x400, s75
    s_max_u32 s73, s85, 1
    s_sub_u32 s73, s73, 1
    s_lshl_b32 s73, s73, 10
    s_lshr_b32 s74, s2, 3
    s_lshl_b32 s74, s74, 4
    s_mul_i32 s74, s74, s75
    s_add_u32 s73, s73, s74
    v_mul_u32_u24 v2, s75, v0
    s_mov_b64 exec, 0xffff
    buffer_load_dword v19, v2, s[40:43], s73 offen offset:384
    s_mov_b64 exec, -1
    s_cmp_eq_u32 s85, 0
    s_cbranch_scc1 xs_1
    s_add_u32 s73, s83, s85
    s_add_u32 s73, s73, 0
    s_and_b32 s73, s73, 7
    s_lshl_b32 s73, s73, 7
    s_add_u32 s73, s73, s79
    s_add_u32 m0, s78, 65536
    s_nop 0
    buffer_load_dwordx4 v17, s[28:31], s73 offen lds
    s_add_u32 m0, s78, 66560
    s_add_u32 s73, s73, 8192
    buffer_load_dwordx4 v18, s[28:31], s73 offen lds
    s_add_u32 m0, s78, 67584
    s_add_u32 s73, s73, 8192
    buffer_load_dwordx4 v17, s[28:31], s73 offen lds
    s_add_u32 m0, s78, 68608
    s_add_u32 s73, s73, 8192
    buffer_load_dwordx4 v18, s[28:31], s73 offen lds
    s_add_u32 m0, s78, 69632
    s_add_u32 s73, s73, 8192
    buffer_load_dwordx4 v17, s[28:31], s73 offen lds
    s_add_u32 m0, s78, 70656
    s_add_u32 s73, s73, 8192
    buffer_load_dwordx4 v18, s[28:31], s73 offen lds
    s_add_u32 m0, s78, 71680
    s_add_u32 s73, s73, 8192
    buffer_load_dwordx4 v17, s[28:31], s73 offen lds
    s_add_u32 m0, s78, 72704
    s_add_u32 s73, s73, 8192
    buffer_load_dwordx4 v18, s[28:31], s73 offen lds
xs_1:
    s_add_u32 s73, s83, s85
    s_add_u32 s73, s73, 4
    s_and_b32 s73, s73, 7
    s_lshl_b32 s73, s73, 7
    s_add_u32 s73, s73, s79
    s_add_u32 m0, s78, 98304
    s_nop 0
    buffer_load_dwordx4 v17, s[28:31], s73 offen lds
    s_add_u32 m0, s78, 99328
    s_add_u32 s73, s73, 8192
    buffer_load_dwordx4 v18, s[28:31], s73 offen lds
    s_add_u32 m0, s78, 100352
    s_add_u32 s73, s73, 8192
    buffer_load_dwordx4 v17, s[28:31], s73 offen lds
    s_add_u32 m0, s78, 101376
    s_add_u32 s73, s73, 8192
    buffer_load_dwordx4 v18, s[28:31], s73 offen lds
    s_add_u32 m0, s78, 102400
    s_add_u32 s73, s73, 8192
    buffer_load_dwordx4 v17, s[28:31], s73 offen lds
    s_add_u32 m0, s78, 103424
    s_add_u32 s73, s73, 8192
    buffer_load_dwordx4 v18, s[28:31], s73 offen lds
    s_add_u32 m0, s78, 104448
    s_add_u32 s73, s73, 8192
    buffer_load_dwordx4 v17, s[28:31], s73 offen lds
    s_add_u32 m0, s78, 105472
    s_add_u32 s73, s73, 8192
    buffer_load_dwordx4 v18, s[28:31], s73 offen lds
    s_waitcnt vmcnt(8)
    s_lshl_b32 s72, s85, 2
    s_add_u32 s72, s72, 163344
    v_mov_b32 v2, s72
    v_mov_b32 v3, 1
    s_mov_b64 exec, 1
    ds_write_b32 v2, v3
    s_mov_b64 exec, -1
    s_waitcnt vmcnt(0)
    s_lshl_b32 s72, s85, 2
    s_add_u32 s72, s72, 163360
    v_mov_b32 v2, s72
    v_mov_b32 v3, 1
    s_mov_b64 exec, 1
    ds_write_b32 v2, v3
    s_mov_b64 exec, -1
    v_and_b32 v2, 3, v0
    v_lshlrev_b32 v2, 2, v2
    v_add_u32 v2, 163392, v2
    s_mov_b32 s84, 400000
tw_3:
    ds_read_b32 v3, v2
    s_waitcnt lgkmcnt(0)
    v_cmp_ne_u32 vcc, 1, v3
    s_cbranch_vccz twd_4
    s_sub_u32 s84, s84, 1
    s_cbranch_scc1 twd_4
    s_sleep 4
    s_branch tw_3
twd_4:
    ds_read_b32 v2, v1 offset:32372
    s_waitcnt lgkmcnt(0)
    v_readfirstlane_b32 s71, v2
    s_setprio 3
    s_lshl_b32 s72, s85, 11
    s_add_u32 s72, s72, 8192
    v_add_u32 v3, s72, v160
    ds_read_b128 v[16:19], v3 offset:0
    ds_read_b128 v[20:23], v3 offset:1024
    s_lshl_b32 s72, s69, 8
    s_add_u32 s72, s72, 0x1c000
    buffer_load_dword v61, v8, s[60:63], s72 offen sc1
    buffer_load_dword v62, v8, s[60:63], s72 offen offset:128 sc1
    s_waitcnt lgkmcnt(0)
    s_lshr_b32 s73, s2, 3
    s_add_u32 s73, s73, 4
    s_and_b32 s73, s73, 3
    s_lshl_b32 s73, s73, 2
    s_add_u32 s73, s73, s85
    s_lshl_b32 s73, s73, 12
    s_lshl_b32 s74, s85, 12
    s_add_u32 m0, s74, 65536
    s_add_u32 s73, s73, 0x30000
    buffer_load_dwordx4 v160, s[60:63], s73 offen offset:0 sc1 lds
    buffer_load_dwordx4 v160, s[60:63], s73 offen offset:1024 sc1 lds
    buffer_load_dwordx4 v160, s[60:63], s73 offen offset:2048 sc1 lds
    buffer_load_dwordx4 v160, s[60:63], s73 offen offset:3072 sc1 lds
    s_lshr_b32 s73, s2, 3
    s_add_u32 s73, s73, 5
    s_and_b32 s73, s73, 3
    s_lshl_b32 s73, s73, 2
    s_add_u32 s73, s73, s85
    s_lshl_b32 s73, s73, 12
    s_lshl_b32 s74, s85, 12
    s_add_u32 m0, s74, 81920
    s_add_u32 s73, s73, 0x30000
    buffer_load_dwordx4 v160, s[60:63], s73 offen offset:0 sc1 lds
    buffer_load_dwordx4 v160, s[60:63], s73 offen offset:1024 sc1 lds
    buffer_load_dwordx4 v160, s[60:63], s73 offen offset:2048 sc1 lds
    buffer_load_dwordx4 v160, s[60:63], s73 offen offset:3072 sc1 lds
    s_lshr_b32 s73, s2, 3
    s_add_u32 s73, s73, 6
    s_and_b32 s73, s73, 3
    s_lshl_b32 s73, s73, 2
    s_add_u32 s73, s73, s85
    s_lshl_b32 s73, s73, 12
    s_lshl_b32 s74, s85, 12
    s_add_u32 m0, s74, 98304
    s_add_u32 s73, s73, 0x30000
    buffer_load_dwordx4 v160, s[60:63], s73 offen offset:0 sc1 lds
    buffer_load_dwordx4 v160, s[60:63], s73 offen offset:1024 sc1 lds
    buffer_load_dwordx4 v160, s[60:63], s73 offen offset:2048 sc1 lds
    buffer_load_dwordx4 v160, s[60:63], s73 offen offset:3072 sc1 lds
    s_lshr_b32 s73, s2, 3
    s_add_u32 s73, s73, 7
    s_and_b32 s73, s73, 3
    s_lshl_b32 s73, s73, 2
    s_add_u32 s73, s73, s85
    s_lshl_b32 s73, s73, 12
    s_lshl_b32 s74, s85, 12
    s_add_u32 m0, s74, 114688
    s_add_u32 s73, s73, 0x30000
    buffer_load_dwordx4 v160, s[60:63], s73 offen offset:0 sc1 lds
    buffer_load_dwordx4 v160, s[60:63], s73 offen offset:1024 sc1 lds
    buffer_load_dwordx4 v160, s[60:63], s73 offen offset:2048 sc1 lds
    buffer_load_dwordx4 v160, s[60:63], s73 offen offset:3072 sc1 lds
    s_lshl_b32 s82, s69, 6
    s_lshl_b32 s73, s70, 2
    s_add_u32 s82, s82, s73
    s_add_u32 s82, s82, s85
    s_lshl_b32 s82, s82, 10
    v_mov_b32 v12, -1
    v_mov_b32 v13, -1
    v_mov_b32 v14, -1
    v_mov_b32 v15, -1
    s_add_u32 s73, s82, 0x640000
    buffer_store_dwordx4 v[12:15], v160, s[60:63], s73 offen sc1
    s_add_u32 s73, s82, 0x648000
    buffer_store_dwordx4 v[12:15], v160, s[60:63], s73 offen sc1
    s_add_u32 s73, s82, 0x840000
    buffer_store_dwordx4 v[12:15], v160, s[60:63], s73 offen sc1
    s_add_u32 s73, s82, 0x848000
    buffer_store_dwordx4 v[12:15], v160, s[60:63], s73 offen sc1
    s_lshl_b32 s75, s70, 5
    s_add_u32 s75, s75, s69
    s_lshl_b32 s75, s75, 7
    s_lshl_b32 s73, s85, 2
    s_add_u32 s75, s75, s73
    s_add_u32 s75, s75, 0x4010
    s_getreg_b32 s65, hwreg(HW_REG_XCC_ID, 0, 4)
    s_add_u32 s72, s71, s65
    v_mov_b32 v3, s72
    s_waitcnt vmcnt(0)
    s_mov_b64 exec, 1
    buffer_store_dword v3, off, s[60:63], s75 sc1
    s_mov_b64 exec, -1
    v_mov_b32 v2, 257
    s_mov_b64 exec, 1
    ds_add_u32 v1, v2 offset:32016
    s_mov_b64 exec, -1
    v_sub_f32 v61, 1.0, v61
    v_sub_f32 v62, 1.0, v62
    s_mov_b32 s84, 400000
poll_5:
    buffer_load_dwordx2 v[4:5], v162, s[60:63], 0 offen sc1
    s_waitcnt vmcnt(0)
    v_xor_b32 v4, s71, v4
    v_xor_b32 v5, s71, v5
    v_or_b32 v4, v4, v5
    v_cmp_ne_u32 vcc, 0, v4
    s_cbranch_vccz polld_6
    s_sub_u32 s84, s84, 1
    s_cbranch_scc1 polld_6
    s_sleep 3
    s_branch poll_5
polld_6:
    s_lshl_b32 s80, s70, 2
    s_add_u32 s80, s80, s85
    s_lshl_b32 s80, s80, 6
    s_lshl_b32 s81, s69, 1
    s_sub_i32 s81, s81, 8
    s_add_i32 s72, s81, 0
    s_max_i32 s72, s72, 0
    s_add_u32 s72, s72, s80
    s_lshl_b32 s72, s72, 11
    s_add_u32 s72, s72, 0x240000
    buffer_load_dwordx4 v[24:27], v160, s[60:63], s72 offen sc1
    s_mov_b64 exec, s[86:87]
    buffer_load_dwordx4 v[36:39], v161, s[60:63], s72 offen offset:1024 sc1
    buffer_load_dwordx4 v[40:43], v161, s[60:63], s72 offen offset:1536 sc1
    s_mov_b64 exec, -1
    s_add_i32 s72, s81, 1
    s_max_i32 s72, s72, 0
    s_add_u32 s72, s72, s80
    s_lshl_b32 s72, s72, 11
    s_add_u32 s72, s72, 0x240000
    buffer_load_dwordx4 v[28:31], v160, s[60:63], s72 offen sc1
    s_mov_b64 exec, s[86:87]
    buffer_load_dwordx4 v[44:47], v161, s[60:63], s72 offen offset:1024 sc1
    buffer_load_dwordx4 v[48:51], v161, s[60:63], s72 offen offset:1536 sc1
    s_mov_b64 exec, -1
    s_setprio 3
    s_add_i32 s72, s81, 2
    s_max_i32 s72, s72, 0
    s_add_i32 s73, s81, 6
    s_min_i32 s72, s72, s73
    s_cmp_lt_i32 s72, 0
    s_cbranch_scc1 tk_7
    s_add_u32 s72, s72, s80
    s_lshl_b32 s72, s72, 11
    s_add_u32 s72, s72, 0x240000
    buffer_load_dword v3, v163, s[60:63], s72 offen sc1
tk_7:
    s_add_i32 s72, s81, 6
    s_max_i32 s72, s72, 0
    s_add_i32 s73, s81, 6
    s_min_i32 s72, s72, s73
    s_cmp_lt_i32 s72, 0
    s_cbranch_scc1 tk_8
    s_add_u32 s72, s72, s80
    s_lshl_b32 s72, s72, 11
    s_add_u32 s72, s72, 0x240000
    buffer_load_dword v3, v163, s[60:63], s72 offen sc1
tk_8:
    s_waitcnt lgkmcnt(0)
    s_add_i32 s72, s81, 2
    s_max_i32 s72, s72, 0
    s_add_u32 s72, s72, s80
    s_lshl_b32 s72, s72, 11
    s_add_u32 s72, s72, 0x240000
    buffer_load_dwordx4 v[32:35], v160, s[60:63], s72 offen sc1
    s_mov_b64 exec, s[86:87]
    buffer_load_dwordx4 v[52:55], v161, s[60:63], s72 offen offset:1024 sc1
    buffer_load_dwordx4 v[56:59], v161, s[60:63], s72 offen offset:1536 sc1
    s_mov_b64 exec, -1
    s_waitcnt vmcnt(6)
    s_cmp_lt_i32 s81, 0
    s_cbranch_scc1 bskip_9
    v_mfma_f32_32x32x16_bf16 v[64:79], v[24:27], v[16:19], v[128:143]
    s_nop 11
    v_exp_f32 v64, v64
    v_exp_f32 v65, v65
    v_exp_f32 v66, v66
    v_exp_f32 v67, v67
    v_exp_f32 v68, v68
    v_exp_f32 v69, v69
    v_exp_f32 v70, v70
    v_exp_f32 v71, v71
    v_exp_f32 v72, v72
    v_exp_f32 v73, v73
    v_smfmac_f32_32x32x32_bf16 v[96:111], v[36:39], v[64:71], v60
    v_exp_f32 v74, v74
    v_exp_f32 v75, v75
    v_exp_f32 v76, v76
    v_exp_f32 v77, v77
    v_exp_f32 v78, v78
    v_exp_f32 v79, v79
    s_nop 1
    v_smfmac_f32_32x32x32_bf16 v[96:111], v[40:43], v[72:79], v60
bskip_9:
    s_add_i32 s72, s81, 3
    s_max_i32 s72, s72, 0
    s_add_u32 s72, s72, s80
    s_lshl_b32 s72, s72, 11
    s_add_u32 s72, s72, 0x240000
    buffer_load_dwordx4 v[24:27], v160, s[60:63], s72 offen sc1
    s_mov_b64 exec, s[86:87]
    buffer_load_dwordx4 v[36:39], v161, s[60:63], s72 offen offset:1024 sc1
    buffer_load_dwordx4 v[40:43], v161, s[60:63], s72 offen offset:1536 sc1
    s_mov_b64 exec, -1
    s_waitcnt vmcnt(6)
    s_cmp_lt_i32 s81, -1
    s_cbranch_scc1 bskip_10
    v_mfma_f32_32x32x16_bf16 v[64:79], v[28:31], v[16:19], 0
    v_mfma_f32_32x32x16_bf16 v[80:95], v[28:31], v[20:23], v[128:143]
    s_nop 10
    v_exp_f32 v64, v64
    v_exp_f32 v65, v65
    v_exp_f32 v66, v66
    v_exp_f32 v67, v67
    v_exp_f32 v68, v68
    v_exp_f32 v69, v69
    v_exp_f32 v70, v70
    v_exp_f32 v71, v71
    v_exp_f32 v72, v72
    v_exp_f32 v73, v73
    v_smfmac_f32_32x32x32_bf16 v[96:111], v[44:47], v[64:71], v60
    v_exp_f32 v74, v74
    v_exp_f32 v75, v75
    v_exp_f32 v76, v76
    v_exp_f32 v77, v77
    v_exp_f32 v78, v78
    v_exp_f32 v79, v79
    s_nop 1
    v_smfmac_f32_32x32x32_bf16 v[96:111], v[48:51], v[72:79], v60
    v_exp_f32 v80, v80
    v_exp_f32 v81, v81
    v_exp_f32 v82, v82
    v_exp_f32 v83, v83
    v_exp_f32 v84, v84
    v_exp_f32 v85, v85
    v_exp_f32 v86, v86
    v_exp_f32 v87, v87
    v_exp_f32 v88, v88
    v_exp_f32 v89, v89
    v_smfmac_f32_32x32x32_bf16 v[112:127], v[44:47], v[80:87], v60
    v_exp_f32 v90, v90
    v_exp_f32 v91, v91
    v_exp_f32 v92, v92
    v_exp_f32 v93, v93
    v_exp_f32 v94, v94
    v_exp_f32 v95, v95
    s_nop 1
    v_smfmac_f32_32x32x32_bf16 v[112:127], v[48:51], v[88:95], v60
bskip_10:
    s_add_i32 s72, s81, 4
    s_max_i32 s72, s72, 0
    s_add_u32 s72, s72, s80
    s_lshl_b32 s72, s72, 11
    s_add_u32 s72, s72, 0x240000
    buffer_load_dwordx4 v[28:31], v160, s[60:63], s72 offen sc1
    s_mov_b64 exec, s[86:87]
    buffer_load_dwordx4 v[44:47], v161, s[60:63], s72 offen offset:1024 sc1
    buffer_load_dwordx4 v[48:51], v161, s[60:63], s72 offen offset:1536 sc1
    s_mov_b64 exec, -1
    s_waitcnt vmcnt(6)
    s_cmp_lt_i32 s81, -2
    s_cbranch_scc1 bskip_11
    v_mfma_f32_32x32x16_bf16 v[64:79], v[32:35], v[16:19], 0
    v_mfma_f32_32x32x16_bf16 v[80:95], v[32:35], v[20:23], 0
    s_nop 10
    v_exp_f32 v64, v64
    v_exp_f32 v65, v65
    v_exp_f32 v66, v66
    v_exp_f32 v67, v67
    v_exp_f32 v68, v68
    v_exp_f32 v69, v69
    v_exp_f32 v70, v70
    v_exp_f32 v71, v71
    v_exp_f32 v72, v72
    v_exp_f32 v73, v73
    v_smfmac_f32_32x32x32_bf16 v[96:111], v[52:55], v[64:71], v60
    v_exp_f32 v74, v74
    v_exp_f32 v75, v75
    v_exp_f32 v76, v76
    v_exp_f32 v77, v77
    v_exp_f32 v78, v78
    v_exp_f32 v79, v79
    s_nop 1
    v_smfmac_f32_32x32x32_bf16 v[96:111], v[56:59], v[72:79], v60
    v_exp_f32 v80, v80
    v_exp_f32 v81, v81
    v_exp_f32 v82, v82
    v_exp_f32 v83, v83
    v_exp_f32 v84, v84
    v_exp_f32 v85, v85
    v_exp_f32 v86, v86
    v_exp_f32 v87, v87
    v_exp_f32 v88, v88
    v_exp_f32 v89, v89
    v_smfmac_f32_32x32x32_bf16 v[112:127], v[52:55], v[80:87], v60
    v_exp_f32 v90, v90
    v_exp_f32 v91, v91
    v_exp_f32 v92, v92
    v_exp_f32 v93, v93
    v_exp_f32 v94, v94
    v_exp_f32 v95, v95
    s_nop 1
    v_smfmac_f32_32x32x32_bf16 v[112:127], v[56:59], v[88:95], v60
bskip_11:
    s_cmp_ge_u32 s85, 2
    s_cbranch_scc0 L_B_NOT
    s_lshr_b32 s73, s2, 3
    s_lshl_b32 s73, s73, 14
    s_and_b32 s74, s85, 1
    s_lshl_b32 s74, s74, 13
    s_add_u32 s73, s73, s74
    buffer_load_dword v3, v163, s[48:51], s73 offen
    buffer_load_dword v3, v163, s[44:47], s73 offen
L_B_NOT:
    s_add_i32 s72, s81, 5
    s_max_i32 s72, s72, 0
    s_add_u32 s72, s72, s80
    s_lshl_b32 s72, s72, 11
    s_add_u32 s72, s72, 0x240000
    buffer_load_dwordx4 v[32:35], v160, s[60:63], s72 offen sc1
    s_mov_b64 exec, s[86:87]
    buffer_load_dwordx4 v[52:55], v161, s[60:63], s72 offen offset:1024 sc1
    buffer_load_dwordx4 v[56:59], v161, s[60:63], s72 offen offset:1536 sc1
    s_mov_b64 exec, -1
    s_waitcnt vmcnt(6)
    s_cmp_lt_i32 s81, -3
    s_cbranch_scc1 bskip_12
    v_mfma_f32_32x32x16_bf16 v[64:79], v[24:27], v[16:19], 0
    v_mfma_f32_32x32x16_bf16 v[80:95], v[24:27], v[20:23], 0
    s_nop 10
    v_exp_f32 v64, v64
    v_exp_f32 v65, v65
    v_exp_f32 v66, v66
    v_exp_f32 v67, v67
    v_exp_f32 v68, v68
    v_exp_f32 v69, v69
    v_exp_f32 v70, v70
    v_exp_f32 v71, v71
    v_exp_f32 v72, v72
    v_exp_f32 v73, v73
    v_smfmac_f32_32x32x32_bf16 v[96:111], v[36:39], v[64:71], v60
    v_exp_f32 v74, v74
    v_exp_f32 v75, v75
    v_exp_f32 v76, v76
    v_exp_f32 v77, v77
    v_exp_f32 v78, v78
    v_exp_f32 v79, v79
    s_nop 1
    v_smfmac_f32_32x32x32_bf16 v[96:111], v[40:43], v[72:79], v60
    v_exp_f32 v80, v80
    v_exp_f32 v81, v81
    v_exp_f32 v82, v82
    v_exp_f32 v83, v83
    v_exp_f32 v84, v84
    v_exp_f32 v85, v85
    v_exp_f32 v86, v86
    v_exp_f32 v87, v87
    v_exp_f32 v88, v88
    v_exp_f32 v89, v89
    v_smfmac_f32_32x32x32_bf16 v[112:127], v[36:39], v[80:87], v60
    v_exp_f32 v90, v90
    v_exp_f32 v91, v91
    v_exp_f32 v92, v92
    v_exp_f32 v93, v93
    v_exp_f32 v94, v94
    v_exp_f32 v95, v95
    s_nop 1
    v_smfmac_f32_32x32x32_bf16 v[112:127], v[40:43], v[88:95], v60
bskip_12:
    s_setprio 3
    s_add_i32 s72, s81, 6
    s_max_i32 s72, s72, 0
    s_add_u32 s72, s72, s80
    s_lshl_b32 s72, s72, 11
    s_add_u32 s72, s72, 0x240000
    buffer_load_dwordx4 v[24:27], v160, s[60:63], s72 offen sc1
    s_mov_b64 exec, s[86:87]
    buffer_load_dwordx4 v[36:39], v161, s[60:63], s72 offen offset:1024 sc1
    buffer_load_dwordx4 v[40:43], v161, s[60:63], s72 offen offset:1536 sc1
    s_mov_b64 exec, -1
    s_waitcnt vmcnt(6)
    s_cmp_lt_i32 s81, -4
    s_cbranch_scc1 bskip_13
    v_mfma_f32_32x32x16_bf16 v[64:79], v[28:31], v[16:19], 0
    v_mfma_f32_32x32x16_bf16 v[80:95], v[28:31], v[20:23], 0
    s_nop 10
    v_exp_f32 v64, v64
    v_exp_f32 v65, v65
    v_exp_f32 v66, v66
    v_exp_f32 v67, v67
    v_exp_f32 v68, v68
    v_exp_f32 v69, v69
    v_exp_f32 v70, v70
    v_exp_f32 v71, v71
    v_exp_f32 v72, v72
    v_exp_f32 v73, v73
    v_smfmac_f32_32x32x32_bf16 v[96:111], v[44:47], v[64:71], v60
    v_exp_f32 v74, v74
    v_exp_f32 v75, v75
    v_exp_f32 v76, v76
    v_exp_f32 v77, v77
    v_exp_f32 v78, v78
    v_exp_f32 v79, v79
    s_nop 1
    v_smfmac_f32_32x32x32_bf16 v[96:111], v[48:51], v[72:79], v60
    v_exp_f32 v80, v80
    v_exp_f32 v81, v81
    v_exp_f32 v82, v82
    v_exp_f32 v83, v83
    v_exp_f32 v84, v84
    v_exp_f32 v85, v85
    v_exp_f32 v86, v86
    v_exp_f32 v87, v87
    v_exp_f32 v88, v88
    v_exp_f32 v89, v89
    v_smfmac_f32_32x32x32_bf16 v[112:127], v[44:47], v[80:87], v60
    v_exp_f32 v90, v90
    v_exp_f32 v91, v91
    v_exp_f32 v92, v92
    v_exp_f32 v93, v93
    v_exp_f32 v94, v94
    v_exp_f32 v95, v95
    s_nop 1
    v_smfmac_f32_32x32x32_bf16 v[112:127], v[48:51], v[88:95], v60
bskip_13:
    s_add_i32 s72, s81, 7
    s_max_i32 s72, s72, 0
    s_add_u32 s72, s72, s80
    s_lshl_b32 s72, s72, 11
    s_add_u32 s72, s72, 0x240000
    buffer_load_dwordx4 v[28:31], v160, s[60:63], s72 offen sc1
    s_mov_b64 exec, s[86:87]
    buffer_load_dwordx4 v[44:47], v161, s[60:63], s72 offen offset:1024 sc1
    buffer_load_dwordx4 v[48:51], v161, s[60:63], s72 offen offset:1536 sc1
    s_mov_b64 exec, -1
    s_waitcnt vmcnt(6)
    s_cmp_lt_i32 s81, -5
    s_cbranch_scc1 bskip_14
    v_mfma_f32_32x32x16_bf16 v[64:79], v[32:35], v[16:19], 0
    v_mfma_f32_32x32x16_bf16 v[80:95], v[32:35], v[20:23], 0
    s_nop 10
    v_exp_f32 v64, v64
    v_exp_f32 v65, v65
    v_exp_f32 v66, v66
    v_exp_f32 v67, v67
    v_exp_f32 v68, v68
    v_exp_f32 v69, v69
    v_exp_f32 v70, v70
    v_exp_f32 v71, v71
    v_exp_f32 v72, v72
    v_exp_f32 v73, v73
    v_smfmac_f32_32x32x32_bf16 v[96:111], v[52:55], v[64:71], v60
    v_exp_f32 v74, v74
    v_exp_f32 v75, v75
    v_exp_f32 v76, v76
    v_exp_f32 v77, v77
    v_exp_f32 v78, v78
    v_exp_f32 v79, v79
    s_nop 1
    v_smfmac_f32_32x32x32_bf16 v[96:111], v[56:59], v[72:79], v60
    v_exp_f32 v80, v80
    v_exp_f32 v81, v81
    v_exp_f32 v82, v82
    v_exp_f32 v83, v83
    v_exp_f32 v84, v84
    v_exp_f32 v85, v85
    v_exp_f32 v86, v86
    v_exp_f32 v87, v87
    v_exp_f32 v88, v88
    v_exp_f32 v89, v89
    v_smfmac_f32_32x32x32_bf16 v[112:127], v[52:55], v[80:87], v60
    v_exp_f32 v90, v90
    v_exp_f32 v91, v91
    v_exp_f32 v92, v92
    v_exp_f32 v93, v93
    v_exp_f32 v94, v94
    v_exp_f32 v95, v95
    s_nop 1
    v_smfmac_f32_32x32x32_bf16 v[112:127], v[56:59], v[88:95], v60
bskip_14:
    s_add_i32 s72, s81, 8
    s_max_i32 s72, s72, 0
    s_add_u32 s72, s72, s80
    s_lshl_b32 s72, s72, 11
    s_add_u32 s72, s72, 0x240000
    buffer_load_dwordx4 v[32:35], v160, s[60:63], s72 offen sc1
    s_mov_b64 exec, s[86:87]
    buffer_load_dwordx4 v[52:55], v161, s[60:63], s72 offen offset:1024 sc1
    buffer_load_dwordx4 v[56:59], v161, s[60:63], s72 offen offset:1536 sc1
    s_mov_b64 exec, -1
    s_waitcnt vmcnt(6)
    s_cmp_lt_i32 s81, -6
    s_cbranch_scc1 bskip_15
    v_mfma_f32_32x32x16_bf16 v[64:79], v[24:27], v[16:19], 0
    v_mfma_f32_32x32x16_bf16 v[80:95], v[24:27], v[20:23], 0
    s_nop 10
    v_exp_f32 v64, v64
    v_exp_f32 v65, v65
    v_exp_f32 v66, v66
    v_exp_f32 v67, v67
    v_exp_f32 v68, v68
    v_exp_f32 v69, v69
    v_exp_f32 v70, v70
    v_exp_f32 v71, v71
    v_exp_f32 v72, v72
    v_exp_f32 v73, v73
    v_smfmac_f32_32x32x32_bf16 v[96:111], v[36:39], v[64:71], v60
    v_exp_f32 v74, v74
    v_exp_f32 v75, v75
    v_exp_f32 v76, v76
    v_exp_f32 v77, v77
    v_exp_f32 v78, v78
    v_exp_f32 v79, v79
    s_nop 1
    v_smfmac_f32_32x32x32_bf16 v[96:111], v[40:43], v[72:79], v60
    v_exp_f32 v80, v80
    v_exp_f32 v81, v81
    v_exp_f32 v82, v82
    v_exp_f32 v83, v83
    v_exp_f32 v84, v84
    v_exp_f32 v85, v85
    v_exp_f32 v86, v86
    v_exp_f32 v87, v87
    v_exp_f32 v88, v88
    v_exp_f32 v89, v89
    v_smfmac_f32_32x32x32_bf16 v[112:127], v[36:39], v[80:87], v60
    v_exp_f32 v90, v90
    v_exp_f32 v91, v91
    v_exp_f32 v92, v92
    v_exp_f32 v93, v93
    v_exp_f32 v94, v94
    v_exp_f32 v95, v95
    s_nop 1
    v_smfmac_f32_32x32x32_bf16 v[112:127], v[40:43], v[88:95], v60
bskip_15:
    buffer_load_dwordx4 v[12:15], v166, s[60:63], 0 offen sc1
    s_add_i32 s72, s81, 9
    s_max_i32 s72, s72, 0
    s_add_u32 s72, s72, s80
    s_lshl_b32 s72, s72, 11
    s_add_u32 s72, s72, 0x240000
    buffer_load_dwordx4 v[24:27], v160, s[60:63], s72 offen sc1
    s_mov_b64 exec, s[86:87]
    buffer_load_dwordx4 v[36:39], v161, s[60:63], s72 offen offset:1024 sc1
    buffer_load_dwordx4 v[40:43], v161, s[60:63], s72 offen offset:1536 sc1
    s_mov_b64 exec, -1
    s_waitcnt vmcnt(6)
    s_cmp_lt_i32 s81, -7
    s_cbranch_scc1 bskip_16
    v_mfma_f32_32x32x16_bf16 v[64:79], v[28:31], v[16:19], 0
    v_mfma_f32_32x32x16_bf16 v[80:95], v[28:31], v[20:23], 0
    s_nop 10
    v_exp_f32 v64, v64
    v_exp_f32 v65, v65
    v_exp_f32 v66, v66
    v_exp_f32 v67, v67
    v_exp_f32 v68, v68
    v_exp_f32 v69, v69
    v_exp_f32 v70, v70
    v_exp_f32 v71, v71
    v_exp_f32 v72, v72
    v_exp_f32 v73, v73
    v_smfmac_f32_32x32x32_bf16 v[96:111], v[44:47], v[64:71], v60
    v_exp_f32 v74, v74
    v_exp_f32 v75, v75
    v_exp_f32 v76, v76
    v_exp_f32 v77, v77
    v_exp_f32 v78, v78
    v_exp_f32 v79, v79
    s_nop 1
    v_smfmac_f32_32x32x32_bf16 v[96:111], v[48:51], v[72:79], v60
    v_exp_f32 v80, v80
    v_exp_f32 v81, v81
    v_exp_f32 v82, v82
    v_exp_f32 v83, v83
    v_exp_f32 v84, v84
    v_exp_f32 v85, v85
    v_exp_f32 v86, v86
    v_exp_f32 v87, v87
    v_exp_f32 v88, v88
    v_exp_f32 v89, v89
    v_smfmac_f32_32x32x32_bf16 v[112:127], v[44:47], v[80:87], v60
    v_exp_f32 v90, v90
    v_exp_f32 v91, v91
    v_exp_f32 v92, v92
    v_exp_f32 v93, v93
    v_exp_f32 v94, v94
    v_exp_f32 v95, v95
    s_nop 1
    v_smfmac_f32_32x32x32_bf16 v[112:127], v[48:51], v[88:95], v60
bskip_16:
    s_waitcnt vmcnt(3)
    v_mfma_f32_32x32x16_bf16 v[64:79], v[32:35], v[16:19], v[144:159]
    v_mfma_f32_32x32x16_bf16 v[80:95], v[32:35], v[20:23], 0
    s_nop 10
    v_exp_f32 v64, v64
    v_exp_f32 v65, v65
    v_exp_f32 v66, v66
    v_exp_f32 v67, v67
    v_exp_f32 v68, v68
    v_exp_f32 v69, v69
    v_exp_f32 v70, v70
    v_exp_f32 v71, v71
    v_exp_f32 v72, v72
    v_exp_f32 v73, v73
    v_smfmac_f32_32x32x32_bf16 v[96:111], v[52:55], v[64:71], v60
    v_exp_f32 v74, v74
    v_exp_f32 v75, v75
    v_exp_f32 v76, v76
    v_exp_f32 v77, v77
    v_exp_f32 v78, v78
    v_exp_f32 v79, v79
    s_nop 1
    v_smfmac_f32_32x32x32_bf16 v[96:111], v[56:59], v[72:79], v60
    v_exp_f32 v80, v80
    v_exp_f32 v81, v81
    v_exp_f32 v82, v82
    v_exp_f32 v83, v83
    v_exp_f32 v84, v84
    v_exp_f32 v85, v85
    v_exp_f32 v86, v86
    v_exp_f32 v87, v87
    v_exp_f32 v88, v88
    v_exp_f32 v89, v89
    v_smfmac_f32_32x32x32_bf16 v[112:127], v[52:55], v[80:87], v60
    v_exp_f32 v90, v90
    v_exp_f32 v91, v91
    v_exp_f32 v92, v92
    v_exp_f32 v93, v93
    v_exp_f32 v94, v94
    v_exp_f32 v95, v95
    s_nop 1
    v_smfmac_f32_32x32x32_bf16 v[112:127], v[56:59], v[88:95], v60
    s_waitcnt vmcnt(0)
    v_mfma_f32_32x32x16_bf16 v[80:95], v[24:27], v[20:23], v[144:159]
    s_nop 11
    v_exp_f32 v80, v80
    v_exp_f32 v81, v81
    v_exp_f32 v82, v82
    v_exp_f32 v83, v83
    v_exp_f32 v84, v84
    v_exp_f32 v85, v85
    v_exp_f32 v86, v86
    v_exp_f32 v87, v87
    v_exp_f32 v88, v88
    v_exp_f32 v89, v89
    v_smfmac_f32_32x32x32_bf16 v[112:127], v[36:39], v[80:87], v60
    v_exp_f32 v90, v90
    v_exp_f32 v91, v91
    v_exp_f32 v92, v92
    v_exp_f32 v93, v93
    v_exp_f32 v94, v94
    v_exp_f32 v95, v95
    s_nop 1
    v_smfmac_f32_32x32x32_bf16 v[112:127], v[40:43], v[88:95], v60
    s_add_u32 s82, s82, 0x840000
    s_mov_b32 s84, 400000
    s_branch L_B_PP1
L_B_PP:
    buffer_load_dwordx4 v[12:15], v166, s[60:63], 0 offen sc1
    s_waitcnt vmcnt(0)
L_B_PP1:
    v_subrev_u32 v12, s71, v12
    v_subrev_u32 v13, s71, v13
    v_subrev_u32 v14, s71, v14
    v_subrev_u32 v15, s71, v15
    v_or3_b32 v2, v12, v13, v14
    v_or_b32 v2, v2, v15
    v_cmp_lt_u32 vcc, 15, v2
    s_cbranch_vccz L_B_PPD
    s_sub_u32 s84, s84, 1
    s_cbranch_scc1 L_B_PPD
    s_sleep 3
    s_branch L_B_PP
L_B_PPD:
    v_cmp_ne_u32 vcc, s65, v12
    s_cbranch_vccnz L_B_NLOC
    v_mov_b32 v2, 1
    s_mov_b64 exec, 1
    ds_add_u32 v1, v2 offset:32044
    s_mov_b64 exec, -1
L_B_NLOC:
    v_add_f32 v2, |v96|, |v97|
    v_add_f32 v2, v2, |v98|
    v_add_f32 v2, v2, |v99|
    v_add_f32 v2, v2, |v100|
    v_add_f32 v2, v2, |v101|
    v_add_f32 v2, v2, |v102|
    v_add_f32 v2, v2, |v103|
    v_mov_b32 v3, 0x7f800000
    v_cmp_nlt_f32 s[72:73], v2, v3
    v_cmp_nle_f32 vcc, 0x33800000, v104
    s_or_b64 s[72:73], s[72:73], vcc
    v_cmp_nge_f32 vcc, 0x5d800000, v104
    s_or_b64 s[72:73], s[72:73], vcc
    s_cbranch_scc1 L_FB_B0
L_FB_B0_BACK:
    v_rcp_f32 v2, v104
    s_nop 0
    v_mul_f32 v2, v2, v61
    v_pk_mul_f32 v[96:97], v[96:97], v[2:3] op_sel_hi:[1,0]
    v_pk_mul_f32 v[98:99], v[98:99], v[2:3] op_sel_hi:[1,0]
    v_pk_mul_f32 v[100:101], v[100:101], v[2:3] op_sel_hi:[1,0]
    v_pk_mul_f32 v[102:103], v[102:103], v[2:3] op_sel_hi:[1,0]
    v_cvt_pk_bf16_f32 v4, v96, v97
    v_cvt_pk_bf16_f32 v5, v98, v99
    v_cvt_pk_bf16_f32 v6, v100, v101
    v_cvt_pk_bf16_f32 v7, v102, v103
    v_min_u32 v4, -2, v4
    buffer_store_dwordx4 v[4:7], v160, s[60:63], s82 offen sc1
    s_add_u32 s82, s82, 32768
    s_nop 0
    v_add_f32 v2, |v112|, |v113|
    v_add_f32 v2, v2, |v114|
    v_add_f32 v2, v2, |v115|
    v_add_f32 v2, v2, |v116|
    v_add_f32 v2, v2, |v117|
    v_add_f32 v2, v2, |v118|
    v_add_f32 v2, v2, |v119|
    v_mov_b32 v3, 0x7f800000
    v_cmp_nlt_f32 s[72:73], v2, v3
    v_cmp_nle_f32 vcc, 0x33800000, v120
    s_or_b64 s[72:73], s[72:73], vcc
    v_cmp_nge_f32 vcc, 0x5d800000, v120
    s_or_b64 s[72:73], s[72:73], vcc
    s_cbranch_scc1 L_FB_B1
L_FB_B1_BACK:
    v_rcp_f32 v2, v120
    s_nop 0
    v_mul_f32 v2, v2, v62
    v_pk_mul_f32 v[112:113], v[112:113], v[2:3] op_sel_hi:[1,0]
    v_pk_mul_f32 v[114:115], v[114:115], v[2:3] op_sel_hi:[1,0]
    v_pk_mul_f32 v[116:117], v[116:117], v[2:3] op_sel_hi:[1,0]
    v_pk_mul_f32 v[118:119], v[118:119], v[2:3] op_sel_hi:[1,0]
    v_cvt_pk_bf16_f32 v4, v112, v113
    v_cvt_pk_bf16_f32 v5, v114, v115
    v_cvt_pk_bf16_f32 v6, v116, v117
    v_cvt_pk_bf16_f32 v7, v118, v119
    v_min_u32 v4, -2, v4
    buffer_store_dwordx4 v[4:7], v160, s[60:63], s82 offen sc1
    s_setprio 3
    s_mov_b32 s84, 400000
spin_35:
    ds_read_b32 v2, v1 offset:32024
    s_waitcnt lgkmcnt(0)
    v_readfirstlane_b32 s72, v2
    s_cmp_eq_u32 s72, 0x8
    s_cbranch_scc1 spind_36
    s_sub_u32 s84, s84, 1
    s_cbranch_scc1 spind_36
    s_sleep 6
    s_branch spin_35
spind_36:
    s_lshl_b32 s72, s85, 14
    s_lshl_b32 s73, s85, 17
    s_add_u32 m0, s72, 0
    s_add_u32 s74, s73, 0
    buffer_load_dwordx4 v10, s[48:51], s74 offen lds
    s_add_u32 m0, s72, 1024
    s_add_u32 s74, s73, 8192
    buffer_load_dwordx4 v10, s[48:51], s74 offen lds
    s_add_u32 m0, s72, 2048
    s_add_u32 s74, s73, 16384
    buffer_load_dwordx4 v10, s[48:51], s74 offen lds
    s_add_u32 m0, s72, 3072
    s_add_u32 s74, s73, 24576
    buffer_load_dwordx4 v10, s[48:51], s74 offen lds
    s_add_u32 m0, s72, 4096
    s_add_u32 s74, s73, 32768
    buffer_load_dwordx4 v10, s[48:51], s74 offen lds
    s_add_u32 m0, s72, 5120
    s_add_u32 s74, s73, 40960
    buffer_load_dwordx4 v10, s[48:51], s74 offen lds
    s_add_u32 m0, s72, 6144
    s_add_u32 s74, s73, 49152
    buffer_load_dwordx4 v10, s[48:51], s74 offen lds
    s_add_u32 m0, s72, 7168
    s_add_u32 s74, s73, 57344
    buffer_load_dwordx4 v10, s[48:51], s74 offen lds
    s_add_u32 m0, s72, 8192
    s_add_u32 s74, s73, 65536
    buffer_load_dwordx4 v10, s[48:51], s74 offen lds
    s_add_u32 m0, s72, 9216
    s_add_u32 s74, s73, 73728
    buffer_load_dwordx4 v10, s[48:51], s74 offen lds
    s_add_u32 m0, s72, 10240
    s_add_u32 s74, s73, 81920
    buffer_load_dwordx4 v10, s[48:51], s74 offen lds
    s_add_u32 m0, s72, 11264
    s_add_u32 s74, s73, 90112
    buffer_load_dwordx4 v10, s[48:51], s74 offen lds
    s_add_u32 m0, s72, 12288
    s_add_u32 s74, s73, 98304
    buffer_load_dwordx4 v10, s[48:51], s74 offen lds
    s_add_u32 m0, s72, 13312
    s_add_u32 s74, s73, 106496
    buffer_load_dwordx4 v10, s[48:51], s74 offen lds
    s_add_u32 m0, s72, 14336
    s_add_u32 s74, s73, 114688
    buffer_load_dwordx4 v10, s[48:51], s74 offen lds
    s_add_u32 m0, s72, 15360
    s_add_u32 s74, s73, 122880
    buffer_load_dwordx4 v10, s[48:51], s74 offen lds
    s_add_u32 s72, s67, 0
    buffer_load_dwordx4 v[96:99], v160, s[60:63], s72 offen offset:0 sc1
    buffer_load_dwordx4 v[100:103], v160, s[60:63], s72 offen offset:1024 sc1
    buffer_load_dwordx4 v[104:107], v160, s[60:63], s72 offen offset:2048 sc1
    buffer_load_dwordx4 v[108:111], v160, s[60:63], s72 offen offset:3072 sc1
    s_add_u32 s72, s67, 4096
    buffer_load_dwordx4 v[112:115], v160, s[60:63], s72 offen offset:0 sc1
    buffer_load_dwordx4 v[116:119], v160, s[60:63], s72 offen offset:1024 sc1
    buffer_load_dwordx4 v[120:123], v160, s[60:63], s72 offen offset:2048 sc1
    buffer_load_dwordx4 v[124:127], v160, s[60:63], s72 offen offset:3072 sc1
    s_add_u32 s72, s67, 8192
    buffer_load_dwordx4 v[128:131], v160, s[60:63], s72 offen offset:0 sc1
    buffer_load_dwordx4 v[132:135], v160, s[60:63], s72 offen offset:1024 sc1
    buffer_load_dwordx4 v[136:139], v160, s[60:63], s72 offen offset:2048 sc1
    buffer_load_dwordx4 v[140:143], v160, s[60:63], s72 offen offset:3072 sc1
    s_add_u32 s72, s67, 12288
    buffer_load_dwordx4 v[144:147], v160, s[60:63], s72 offen offset:0 sc1
    buffer_load_dwordx4 v[148:151], v160, s[60:63], s72 offen offset:1024 sc1
    buffer_load_dwordx4 v[152:155], v160, s[60:63], s72 offen offset:2048 sc1
    buffer_load_dwordx4 v[156:159], v160, s[60:63], s72 offen offset:3072 sc1
    s_waitcnt vmcnt(16)
    v_mov_b32 v2, 1
    s_mov_b64 exec, 1
    ds_add_u32 v1, v2 offset:32028
    s_mov_b64 exec, -1
    s_mov_b32 s84, 400000
spin_37:
    ds_read_b32 v2, v1 offset:32028
    s_waitcnt lgkmcnt(0)
    v_readfirstlane_b32 s72, v2
    s_cmp_eq_u32 s72, 0x4
    s_cbranch_scc1 spind_38
    s_sub_u32 s84, s84, 1
    s_cbranch_scc1 spind_38
    s_sleep 2
    s_branch spin_37
spind_38:
    s_branch L_B_GEMM1
L_B_GEMM:
    s_add_u32 s72, s67, 0
    buffer_load_dwordx4 v[96:99], v160, s[60:63], s72 offen offset:0 sc1
    buffer_load_dwordx4 v[100:103], v160, s[60:63], s72 offen offset:1024 sc1
    buffer_load_dwordx4 v[104:107], v160, s[60:63], s72 offen offset:2048 sc1
    buffer_load_dwordx4 v[108:111], v160, s[60:63], s72 offen offset:3072 sc1
    s_add_u32 s72, s67, 4096
    buffer_load_dwordx4 v[112:115], v160, s[60:63], s72 offen offset:0 sc1
    buffer_load_dwordx4 v[116:119], v160, s[60:63], s72 offen offset:1024 sc1
    buffer_load_dwordx4 v[120:123], v160, s[60:63], s72 offen offset:2048 sc1
    buffer_load_dwordx4 v[124:127], v160, s[60:63], s72 offen offset:3072 sc1
    s_add_u32 s72, s67, 8192
    buffer_load_dwordx4 v[128:131], v160, s[60:63], s72 offen offset:0 sc1
    buffer_load_dwordx4 v[132:135], v160, s[60:63], s72 offen offset:1024 sc1
    buffer_load_dwordx4 v[136:139], v160, s[60:63], s72 offen offset:2048 sc1
    buffer_load_dwordx4 v[140:143], v160, s[60:63], s72 offen offset:3072 sc1
    s_add_u32 s72, s67, 12288
    buffer_load_dwordx4 v[144:147], v160, s[60:63], s72 offen offset:0 sc1
    buffer_load_dwordx4 v[148:151], v160, s[60:63], s72 offen offset:1024 sc1
    buffer_load_dwordx4 v[152:155], v160, s[60:63], s72 offen offset:2048 sc1
    buffer_load_dwordx4 v[156:159], v160, s[60:63], s72 offen offset:3072 sc1
L_B_GEMM1:
    ds_read_b64_tr_b16 v[80:81], v11 offset:0
    ds_read_b64_tr_b16 v[82:83], v11 offset:1024
    ds_read_b64_tr_b16 v[84:85], v9 offset:0
    ds_read_b64_tr_b16 v[86:87], v9 offset:1024
    s_mov_b32 s84, 400000
L_B_G0:
    s_waitcnt vmcnt(12)
    v_max_u32 v2, v96, v100
    v_max3_u32 v2, v104, v108, v2
    v_cmp_eq_u32 vcc, -1, v2
    s_cbranch_vccnz L_B_R0
L_B_K0:
    ds_read_b64_tr_b16 v[88:89], v11 offset:2048
    ds_read_b64_tr_b16 v[90:91], v11 offset:3072
    ds_read_b64_tr_b16 v[92:93], v9 offset:2048
    ds_read_b64_tr_b16 v[94:95], v9 offset:3072
    s_waitcnt lgkmcnt(4)
    s_cmp_eq_u32 s64, 0
    s_cbranch_scc0 L_B_M1
    v_mfma_f32_32x32x16_bf16 v[48:63], v[80:83], v[96:99], 0
    v_mfma_f32_32x32x16_bf16 v[64:79], v[84:87], v[96:99], 0
    s_branch L_B_M2
L_B_M1:
    v_mfma_f32_32x32x16_bf16 v[48:63], v[80:83], v[96:99], v[48:63]
    v_mfma_f32_32x32x16_bf16 v[64:79], v[84:87], v[96:99], v[64:79]
L_B_M2:
    ds_read_b64_tr_b16 v[80:81], v11 offset:4096
    ds_read_b64_tr_b16 v[82:83], v11 offset:5120
    ds_read_b64_tr_b16 v[84:85], v9 offset:4096
    ds_read_b64_tr_b16 v[86:87], v9 offset:5120
    s_waitcnt lgkmcnt(4)
    v_mfma_f32_32x32x16_bf16 v[48:63], v[88:91], v[100:103], v[48:63]
    v_mfma_f32_32x32x16_bf16 v[64:79], v[92:95], v[100:103], v[64:79]
    ds_read_b64_tr_b16 v[88:89], v11 offset:6144
    ds_read_b64_tr_b16 v[90:91], v11 offset:7168
    ds_read_b64_tr_b16 v[92:93], v9 offset:6144
    ds_read_b64_tr_b16 v[94:95], v9 offset:7168
    s_waitcnt lgkmcnt(4)
    v_mfma_f32_32x32x16_bf16 v[48:63], v[80:83], v[104:107], v[48:63]
    v_mfma_f32_32x32x16_bf16 v[64:79], v[84:87], v[104:107], v[64:79]
    ds_read_b64_tr_b16 v[80:81], v11 offset:8192
    ds_read_b64_tr_b16 v[82:83], v11 offset:9216
    ds_read_b64_tr_b16 v[84:85], v9 offset:8192
    ds_read_b64_tr_b16 v[86:87], v9 offset:9216
    s_waitcnt lgkmcnt(4)
    v_mfma_f32_32x32x16_bf16 v[48:63], v[88:91], v[108:111], v[48:63]
    v_mfma_f32_32x32x16_bf16 v[64:79], v[92:95], v[108:111], v[64:79]
L_B_G1:
    s_waitcnt vmcnt(8)
    v_max_u32 v2, v112, v116
    v_max3_u32 v2, v120, v124, v2
    v_cmp_eq_u32 vcc, -1, v2
    s_cbranch_vccnz L_B_R1
L_B_K1:
    ds_read_b64_tr_b16 v[88:89], v11 offset:10240
    ds_read_b64_tr_b16 v[90:91], v11 offset:11264
    ds_read_b64_tr_b16 v[92:93], v9 offset:10240
    ds_read_b64_tr_b16 v[94:95], v9 offset:11264
    s_waitcnt lgkmcnt(4)
    v_mfma_f32_32x32x16_bf16 v[48:63], v[80:83], v[112:115], v[48:63]
    v_mfma_f32_32x32x16_bf16 v[64:79], v[84:87], v[112:115], v[64:79]
    ds_read_b64_tr_b16 v[80:81], v11 offset:12288
    ds_read_b64_tr_b16 v[82:83], v11 offset:13312
    ds_read_b64_tr_b16 v[84:85], v9 offset:12288
    ds_read_b64_tr_b16 v[86:87], v9 offset:13312
    s_waitcnt lgkmcnt(4)
    v_mfma_f32_32x32x16_bf16 v[48:63], v[88:91], v[116:119], v[48:63]
    v_mfma_f32_32x32x16_bf16 v[64:79], v[92:95], v[116:119], v[64:79]
    ds_read_b64_tr_b16 v[88:89], v11 offset:14336
    ds_read_b64_tr_b16 v[90:91], v11 offset:15360
    ds_read_b64_tr_b16 v[92:93], v9 offset:14336
    ds_read_b64_tr_b16 v[94:95], v9 offset:15360
    s_waitcnt lgkmcnt(4)
    v_mfma_f32_32x32x16_bf16 v[48:63], v[80:83], v[120:123], v[48:63]
    v_mfma_f32_32x32x16_bf16 v[64:79], v[84:87], v[120:123], v[64:79]
    ds_read_b64_tr_b16 v[80:81], v11 offset:16384
    ds_read_b64_tr_b16 v[82:83], v11 offset:17408
    ds_read_b64_tr_b16 v[84:85], v9 offset:16384
    ds_read_b64_tr_b16 v[86:87], v9 offset:17408
    s_waitcnt lgkmcnt(4)
    v_mfma_f32_32x32x16_bf16 v[48:63], v[88:91], v[124:127], v[48:63]
    v_mfma_f32_32x32x16_bf16 v[64:79], v[92:95], v[124:127], v[64:79]
L_B_G2:
    s_waitcnt vmcnt(4)
    v_max_u32 v2, v128, v132
    v_max3_u32 v2, v136, v140, v2
    v_cmp_eq_u32 vcc, -1, v2
    s_cbranch_vccnz L_B_R2
L_B_K2:
    ds_read_b64_tr_b16 v[88:89], v11 offset:18432
    ds_read_b64_tr_b16 v[90:91], v11 offset:19456
    ds_read_b64_tr_b16 v[92:93], v9 offset:18432
    ds_read_b64_tr_b16 v[94:95], v9 offset:19456
    s_waitcnt lgkmcnt(4)
    v_mfma_f32_32x32x16_bf16 v[48:63], v[80:83], v[128:131], v[48:63]
    v_mfma_f32_32x32x16_bf16 v[64:79], v[84:87], v[128:131], v[64:79]
    ds_read_b64_tr_b16 v[80:81], v11 offset:20480
    ds_read_b64_tr_b16 v[82:83], v11 offset:21504
    ds_read_b64_tr_b16 v[84:85], v9 offset:20480
    ds_read_b64_tr_b16 v[86:87], v9 offset:21504
    s_waitcnt lgkmcnt(4)
    v_mfma_f32_32x32x16_bf16 v[48:63], v[88:91], v[132:135], v[48:63]
    v_mfma_f32_32x32x16_bf16 v[64:79], v[92:95], v[132:135], v[64:79]
    ds_read_b64_tr_b16 v[88:89], v11 offset:22528
    ds_read_b64_tr_b16 v[90:91], v11 offset:23552
    ds_read_b64_tr_b16 v[92:93], v9 offset:22528
    ds_read_b64_tr_b16 v[94:95], v9 offset:23552
    s_waitcnt lgkmcnt(4)
    v_mfma_f32_32x32x16_bf16 v[48:63], v[80:83], v[136:139], v[48:63]
    v_mfma_f32_32x32x16_bf16 v[64:79], v[84:87], v[136:139], v[64:79]
    ds_read_b64_tr_b16 v[80:81], v11 offset:24576
    ds_read_b64_tr_b16 v[82:83], v11 offset:25600
    ds_read_b64_tr_b16 v[84:85], v9 offset:24576
    ds_read_b64_tr_b16 v[86:87], v9 offset:25600
    s_waitcnt lgkmcnt(4)
    v_mfma_f32_32x32x16_bf16 v[48:63], v[88:91], v[140:143], v[48:63]
    v_mfma_f32_32x32x16_bf16 v[64:79], v[92:95], v[140:143], v[64:79]
L_B_G3:
    s_waitcnt vmcnt(0)
    v_max_u32 v2, v144, v148
    v_max3_u32 v2, v152, v156, v2
    v_cmp_eq_u32 vcc, -1, v2
    s_cbranch_vccnz L_B_R3
L_B_K3:
    ds_read_b64_tr_b16 v[88:89], v11 offset:26624
    ds_read_b64_tr_b16 v[90:91], v11 offset:27648
    ds_read_b64_tr_b16 v[92:93], v9 offset:26624
    ds_read_b64_tr_b16 v[94:95], v9 offset:27648
    s_waitcnt lgkmcnt(4)
    v_mfma_f32_32x32x16_bf16 v[48:63], v[80:83], v[144:147], v[48:63]
    v_mfma_f32_32x32x16_bf16 v[64:79], v[84:87], v[144:147], v[64:79]
    ds_read_b64_tr_b16 v[80:81], v11 offset:28672
    ds_read_b64_tr_b16 v[82:83], v11 offset:29696
    ds_read_b64_tr_b16 v[84:85], v9 offset:28672
    ds_read_b64_tr_b16 v[86:87], v9 offset:29696
    s_waitcnt lgkmcnt(4)
    v_mfma_f32_32x32x16_bf16 v[48:63], v[88:91], v[148:151], v[48:63]
    v_mfma_f32_32x32x16_bf16 v[64:79], v[92:95], v[148:151], v[64:79]
    ds_read_b64_tr_b16 v[88:89], v11 offset:30720
    ds_read_b64_tr_b16 v[90:91], v11 offset:31744
    ds_read_b64_tr_b16 v[92:93], v9 offset:30720
    ds_read_b64_tr_b16 v[94:95], v9 offset:31744
    s_waitcnt lgkmcnt(4)
    v_mfma_f32_32x32x16_bf16 v[48:63], v[80:83], v[152:155], v[48:63]
    v_mfma_f32_32x32x16_bf16 v[64:79], v[84:87], v[152:155], v[64:79]
    s_waitcnt lgkmcnt(0)
    v_mfma_f32_32x32x16_bf16 v[48:63], v[88:91], v[156:159], v[48:63]
    v_mfma_f32_32x32x16_bf16 v[64:79], v[92:95], v[156:159], v[64:79]
    s_cmp_eq_u32 s64, 0
    s_cbranch_scc0 L_B_FIN
    v_mov_b32 v2, 1
    s_mov_b64 exec, 1
    ds_add_u32 v1, v2 offset:32032
    s_mov_b64 exec, -1
    s_add_u32 s67, s67, 0xffe00000
    s_mov_b32 s64, 1
    s_mov_b32 s84, 400000
spin_39:
    ds_read_b32 v2, v1 offset:32032
    s_waitcnt lgkmcnt(0)
    v_readfirstlane_b32 s72, v2
    s_cmp_eq_u32 s72, 0x4
    s_cbranch_scc1 spind_40
    s_sub_u32 s84, s84, 1
    s_cbranch_scc1 spind_40
    s_sleep 2
    s_branch spin_39
spind_40:
    s_lshl_b32 s72, s85, 14
    s_lshl_b32 s73, s85, 17
    s_add_u32 m0, s72, 0
    s_add_u32 s74, s73, 0
    buffer_load_dwordx4 v10, s[44:47], s74 offen lds
    s_add_u32 m0, s72, 1024
    s_add_u32 s74, s73, 8192
    buffer_load_dwordx4 v10, s[44:47], s74 offen lds
    s_add_u32 m0, s72, 2048
    s_add_u32 s74, s73, 16384
    buffer_load_dwordx4 v10, s[44:47], s74 offen lds
    s_add_u32 m0, s72, 3072
    s_add_u32 s74, s73, 24576
    buffer_load_dwordx4 v10, s[44:47], s74 offen lds
    s_add_u32 m0, s72, 4096
    s_add_u32 s74, s73, 32768
    buffer_load_dwordx4 v10, s[44:47], s74 offen lds
    s_add_u32 m0, s72, 5120
    s_add_u32 s74, s73, 40960
    buffer_load_dwordx4 v10, s[44:47], s74 offen lds
    s_add_u32 m0, s72, 6144
    s_add_u32 s74, s73, 49152
    buffer_load_dwordx4 v10, s[44:47], s74 offen lds
    s_add_u32 m0, s72, 7168
    s_add_u32 s74, s73, 57344
    buffer_load_dwordx4 v10, s[44:47], s74 offen lds
    s_add_u32 m0, s72, 8192
    s_add_u32 s74, s73, 65536
    buffer_load_dwordx4 v10, s[44:47], s74 offen lds
    s_add_u32 m0, s72, 9216
    s_add_u32 s74, s73, 73728
    buffer_load_dwordx4 v10, s[44:47], s74 offen lds
    s_add_u32 m0, s72, 10240
    s_add_u32 s74, s73, 81920
    buffer_load_dwordx4 v10, s[44:47], s74 offen lds
    s_add_u32 m0, s72, 11264
    s_add_u32 s74, s73, 90112
    buffer_load_dwordx4 v10, s[44:47], s74 offen lds
    s_add_u32 m0, s72, 12288
    s_add_u32 s74, s73, 98304
    buffer_load_dwordx4 v10, s[44:47], s74 offen lds
    s_add_u32 m0, s72, 13312
    s_add_u32 s74, s73, 106496
    buffer_load_dwordx4 v10, s[44:47], s74 offen lds
    s_add_u32 m0, s72, 14336
    s_add_u32 s74, s73, 114688
    buffer_load_dwordx4 v10, s[44:47], s74 offen lds
    s_add_u32 m0, s72, 15360
    s_add_u32 s74, s73, 122880
    buffer_load_dwordx4 v10, s[44:47], s74 offen lds
    s_waitcnt vmcnt(0)
    s_barrier
    s_branch L_B_GEMM
L_B_FIN:
    s_nop 9
    ds_write_b128 v164, v[64:67] offset:0
    ds_write_b128 v164, v[68:71] offset:1024
    ds_write_b128 v164, v[72:75] offset:2048
    ds_write_b128 v164, v[76:79] offset:3072
    s_waitcnt lgkmcnt(0)
    s_cbranch_execz L_B_NBAR
    s_barrier
L_B_NBAR:
    ds_read_b128 v[16:19], v165 offset:0
    ds_read_b128 v[20:23], v165 offset:1024
    ds_read_b128 v[24:27], v165 offset:2048
    ds_read_b128 v[28:31], v165 offset:3072
    s_waitcnt lgkmcnt(3)
    v_add_f32 v48, v48, v16
    v_add_f32 v49, v49, v17
    v_add_f32 v50, v50, v18
    v_add_f32 v51, v51, v19
    s_waitcnt lgkmcnt(2)
    v_add_f32 v52, v52, v20
    v_add_f32 v53, v53, v21
    v_add_f32 v54, v54, v22
    v_add_f32 v55, v55, v23
    s_waitcnt lgkmcnt(1)
    v_add_f32 v56, v56, v24
    v_add_f32 v57, v57, v25
    v_add_f32 v58, v58, v26
    v_add_f32 v59, v59, v27
    s_waitcnt lgkmcnt(0)
    v_add_f32 v60, v60, v28
    v_add_f32 v61, v61, v29
    v_add_f32 v62, v62, v30
    v_add_f32 v63, v63, v31
    v_cvt_pk_bf16_f32 v48, v48, v49
    v_cvt_pk_bf16_f32 v49, v50, v51
    v_cvt_pk_bf16_f32 v50, v52, v53
    v_cvt_pk_bf16_f32 v51, v54, v55
    v_cvt_pk_bf16_f32 v52, v56, v57
    v_cvt_pk_bf16_f32 v53, v58, v59
    v_cvt_pk_bf16_f32 v54, v60, v61
    v_cvt_pk_bf16_f32 v55, v62, v63
    s_nop 1
    v_permlane32_swap_b32 v48, v50
    v_permlane32_swap_b32 v49, v51
    v_permlane32_swap_b32 v52, v54
    v_permlane32_swap_b32 v53, v55
    buffer_store_dwordx4 v[48:51], v167, s[56:59], s66 offen offset:0
    buffer_store_dwordx4 v[52:55], v167, s[56:59], s66 offen offset:32
    s_endpgm
L_B_R0:
    s_sub_u32 s84, s84, 1
    s_cbranch_scc1 L_B_K0
    s_cmp_eq_u32 s64, 0
    s_cbranch_scc0 L_B_RR0
    s_sleep 8
L_B_RR0:
    s_waitcnt vmcnt(0)
    s_add_u32 s72, s67, 0
    buffer_load_dwordx4 v[96:99], v160, s[60:63], s72 offen offset:0 sc1
    buffer_load_dwordx4 v[100:103], v160, s[60:63], s72 offen offset:1024 sc1
    buffer_load_dwordx4 v[104:107], v160, s[60:63], s72 offen offset:2048 sc1
    buffer_load_dwordx4 v[108:111], v160, s[60:63], s72 offen offset:3072 sc1
    s_add_u32 s72, s67, 4096
    buffer_load_dwordx4 v[112:115], v160, s[60:63], s72 offen offset:0 sc1
    buffer_load_dwordx4 v[116:119], v160, s[60:63], s72 offen offset:1024 sc1
    buffer_load_dwordx4 v[120:123], v160, s[60:63], s72 offen offset:2048 sc1
    buffer_load_dwordx4 v[124:127], v160, s[60:63], s72 offen offset:3072 sc1
    s_add_u32 s72, s67, 8192
    buffer_load_dwordx4 v[128:131], v160, s[60:63], s72 offen offset:0 sc1
    buffer_load_dwordx4 v[132:135], v160, s[60:63], s72 offen offset:1024 sc1
    buffer_load_dwordx4 v[136:139], v160, s[60:63], s72 offen offset:2048 sc1
    buffer_load_dwordx4 v[140:143], v160, s[60:63], s72 offen offset:3072 sc1
    s_add_u32 s72, s67, 12288
    buffer_load_dwordx4 v[144:147], v160, s[60:63], s72 offen offset:0 sc1
    buffer_load_dwordx4 v[148:151], v160, s[60:63], s72 offen offset:1024 sc1
    buffer_load_dwordx4 v[152:155], v160, s[60:63], s72 offen offset:2048 sc1
    buffer_load_dwordx4 v[156:159], v160, s[60:63], s72 offen offset:3072 sc1
    s_branch L_B_G0
L_B_R1:
    s_sub_u32 s84, s84, 1
    s_cbranch_scc1 L_B_K1
    s_cmp_eq_u32 s64, 0
    s_cbranch_scc0 L_B_RR1
    s_sleep 8
L_B_RR1:
    s_waitcnt vmcnt(0)
    s_add_u32 s72, s67, 4096
    buffer_load_dwordx4 v[112:115], v160, s[60:63], s72 offen offset:0 sc1
    buffer_load_dwordx4 v[116:119], v160, s[60:63], s72 offen offset:1024 sc1
    buffer_load_dwordx4 v[120:123], v160, s[60:63], s72 offen offset:2048 sc1
    buffer_load_dwordx4 v[124:127], v160, s[60:63], s72 offen offset:3072 sc1
    s_add_u32 s72, s67, 8192
    buffer_load_dwordx4 v[128:131], v160, s[60:63], s72 offen offset:0 sc1
    buffer_load_dwordx4 v[132:135], v160, s[60:63], s72 offen offset:1024 sc1
    buffer_load_dwordx4 v[136:139], v160, s[60:63], s72 offen offset:2048 sc1
    buffer_load_dwordx4 v[140:143], v160, s[60:63], s72 offen offset:3072 sc1
    s_add_u32 s72, s67, 12288
    buffer_load_dwordx4 v[144:147], v160, s[60:63], s72 offen offset:0 sc1
    buffer_load_dwordx4 v[148:151], v160, s[60:63], s72 offen offset:1024 sc1
    buffer_load_dwordx4 v[152:155], v160, s[60:63], s72 offen offset:2048 sc1
    buffer_load_dwordx4 v[156:159], v160, s[60:63], s72 offen offset:3072 sc1
    s_branch L_B_G1
L_B_R2:
    s_sub_u32 s84, s84, 1
    s_cbranch_scc1 L_B_K2
    s_cmp_eq_u32 s64, 0
    s_cbranch_scc0 L_B_RR2
    s_sleep 8
L_B_RR2:
    s_waitcnt vmcnt(0)
    s_add_u32 s72, s67, 8192
    buffer_load_dwordx4 v[128:131], v160, s[60:63], s72 offen offset:0 sc1
    buffer_load_dwordx4 v[132:135], v160, s[60:63], s72 offen offset:1024 sc1
    buffer_load_dwordx4 v[136:139], v160, s[60:63], s72 offen offset:2048 sc1
    buffer_load_dwordx4 v[140:143], v160, s[60:63], s72 offen offset:3072 sc1
    s_add_u32 s72, s67, 12288
    buffer_load_dwordx4 v[144:147], v160, s[60:63], s72 offen offset:0 sc1
    buffer_load_dwordx4 v[148:151], v160, s[60:63], s72 offen offset:1024 sc1
    buffer_load_dwordx4 v[152:155], v160, s[60:63], s72 offen offset:2048 sc1
    buffer_load_dwordx4 v[156:159], v160, s[60:63], s72 offen offset:3072 sc1
    s_branch L_B_G2
L_B_R3:
    s_sub_u32 s84, s84, 1
    s_cbranch_scc1 L_B_K3
    s_cmp_eq_u32 s64, 0
    s_cbranch_scc0 L_B_RR3
    s_sleep 8
L_B_RR3:
    s_waitcnt vmcnt(0)
    s_add_u32 s72, s67, 12288
    buffer_load_dwordx4 v[144:147], v160, s[60:63], s72 offen offset:0 sc1
    buffer_load_dwordx4 v[148:151], v160, s[60:63], s72 offen offset:1024 sc1
    buffer_load_dwordx4 v[152:155], v160, s[60:63], s72 offen offset:2048 sc1
    buffer_load_dwordx4 v[156:159], v160, s[60:63], s72 offen offset:3072 sc1
    s_branch L_B_G3
L_A:
    v_and_b32 v5, 15, v0
    v_lshlrev_b32 v6, 4, v0
    s_and_b32 s81, s70, 3
    s_cmp_lt_u32 s68, 4
    s_cbranch_scc0 L_A_KV
    s_cmp_eq_u32 s68, 0
    s_cselect_b32 s40, s6, s16
    s_cselect_b32 s41, s7, s17
    s_mov_b32 s42, 1572864
    s_cselect_b32 s42, 524288, s42
    s_mov_b32 s43, 0x20000
    s_movk_i32 s82, 3072
    s_cselect_b32 s82, 0x400, s82
    s_max_u32 s73, s68, 1
    s_sub_u32 s73, s73, 1
    s_lshl_b32 s73, s73, 10
    s_lshl_b32 s74, s70, 7
    s_add_u32 s73, s73, s74
    v_lshrrev_b32 v2, 3, v0
    v_mul_u32_u24 v162, s82, v2
    v_bfe_u32 v2, v0, 4, 1
    v_lshlrev_b32 v2, 2, v2
    v_and_b32 v3, 7, v0
    v_xor_b32 v2, v2, v3
    v_lshl_add_u32 v162, v2, 4, v162
    v_add_u32 v162, s73, v162
    s_and_b32 s83, s69, 3
    s_lshl_b32 s83, s83, 1
    s_add_u32 s83, s83, s70
    s_lshl_b32 s82, s82, 3
    s_lshl_b32 s79, s68, 14
    s_sub_u32 s73, s82, 1024
    v_add_u32 v163, s73, v162
    s_lshl_b32 s82, s82, 1
    s_cmp_eq_u32 s68, 0
    s_cbranch_scc0 L_A_NP0
    s_setprio 3
    L_A_NP0:
    s_add_u32 m0, s79, 0
    s_add_u32 s75, s83, 0
    s_and_b32 s75, s75, 7
    s_lshl_b32 s75, s75, 2
    s_mul_i32 s75, s75, s82
    buffer_load_dwordx4 v162, s[40:43], s75 offen lds
    buffer_load_dwordx4 v163, s[40:43], s75 offen offset:1024 lds
    s_add_u32 m0, s79, 2048
    s_add_u32 s75, s75, s82
    buffer_load_dwordx4 v162, s[40:43], s75 offen lds
    buffer_load_dwordx4 v163, s[40:43], s75 offen offset:1024 lds
    s_add_u32 m0, s79, 4096
    s_add_u32 s75, s75, s82
    buffer_load_dwordx4 v162, s[40:43], s75 offen lds
    buffer_load_dwordx4 v163, s[40:43], s75 offen offset:1024 lds
    s_add_u32 m0, s79, 6144
    s_add_u32 s75, s75, s82
    buffer_load_dwordx4 v162, s[40:43], s75 offen lds
    buffer_load_dwordx4 v163, s[40:43], s75 offen offset:1024 lds
    s_add_u32 m0, s79, 8192
    s_add_u32 s75, s83, 1
    s_and_b32 s75, s75, 7
    s_lshl_b32 s75, s75, 2
    s_mul_i32 s75, s75, s82
    buffer_load_dwordx4 v162, s[40:43], s75 offen lds
    buffer_load_dwordx4 v163, s[40:43], s75 offen offset:1024 lds
    s_add_u32 m0, s79, 10240
    s_add_u32 s75, s75, s82
    buffer_load_dwordx4 v162, s[40:43], s75 offen lds
    buffer_load_dwordx4 v163, s[40:43], s75 offen offset:1024 lds
    s_add_u32 m0, s79, 12288
    s_add_u32 s75, s75, s82
    buffer_load_dwordx4 v162, s[40:43], s75 offen lds
    buffer_load_dwordx4 v163, s[40:43], s75 offen offset:1024 lds
    s_add_u32 m0, s79, 14336
    s_add_u32 s75, s75, s82
    buffer_load_dwordx4 v162, s[40:43], s75 offen lds
    buffer_load_dwordx4 v163, s[40:43], s75 offen offset:1024 lds
    s_branch L_A_NOKV
L_A_KV:
    s_setprio 3
    s_load_dword s71, s[26:27], 0
    s_cmp_lt_u32 s70, 4
    s_cselect_b32 s36, s8, s10
    s_cselect_b32 s37, s9, s11
    s_mov_b32 s38, 16384
    s_mov_b32 s39, 0x20000
    s_and_b32 s75, s68, 3
    s_lshl_b32 s73, s69, 16
    s_lshl_b32 s74, s81, 14
    s_add_u32 s73, s73, s74
    s_lshl_b32 s74, s75, 8
    s_add_u32 s73, s73, s74
    v_lshlrev_b32 v3, 10, v5
    v_and_b32 v4, 48, v0
    v_add_u32 v3, v3, v4
    buffer_load_dwordx4 v[116:119], v3, s[28:31], s73 offen offset:0
    buffer_load_dwordx4 v[120:123], v3, s[28:31], s73 offen offset:64
    buffer_load_dwordx4 v[124:127], v3, s[28:31], s73 offen offset:128
    buffer_load_dwordx4 v[128:131], v3, s[28:31], s73 offen offset:192
    s_mov_b32 s52, s20
    s_mov_b32 s53, s21
    s_mov_b32 s54, 0x400
    s_mov_b32 s55, 0x20000
    buffer_load_dwordx4 v[132:135], v4, s[52:55], s74 offen offset:0
    buffer_load_dwordx4 v[136:139], v4, s[52:55], s74 offen offset:64
    buffer_load_dwordx4 v[140:143], v4, s[52:55], s74 offen offset:128
    buffer_load_dwordx4 v[144:147], v4, s[52:55], s74 offen offset:192
    s_lshl_b32 s72, s75, 12
    s_add_u32 m0, s72, 131072
    s_nop 0
    buffer_load_dwordx4 v6, s[36:39], s72 offen offset:0 lds
    buffer_load_dwordx4 v6, s[36:39], s72 offen offset:1024 lds
    buffer_load_dwordx4 v6, s[36:39], s72 offen offset:2048 lds
    buffer_load_dwordx4 v6, s[36:39], s72 offen offset:3072 lds
L_A_NOKV:
    s_and_b32 s80, s68, 1
    s_lshl_b32 s73, s69, 1
    s_add_u32 s80, s80, s73
    s_lshl_b32 s80, s80, 5
    s_lshl_b32 s73, s70, 2
    s_add_u32 s80, s80, s73
    s_and_b32 s73, s68, 2
    s_add_u32 s80, s80, s73
    s_lshr_b32 s73, s68, 2
    s_add_u32 s80, s80, s73
    s_lshl_b32 s80, s80, 10
    s_add_u32 s80, s80, 0x640000
    v_mov_b32 v1, 131072
    v_lshlrev_b32 v11, 2, v0
    v_lshrrev_b32 v2, 5, v0
    v_lshlrev_b32 v2, 3, v2
    v_bfe_u32 v3, v0, 2, 2
    v_add_u32 v2, v2, v3
    v_lshlrev_b32 v160, 7, v2
    v_bfe_u32 v2, v0, 4, 1
    v_lshlrev_b32 v2, 1, v2
    v_bfe_u32 v3, v0, 1, 1
    v_add3_u32 v2, v2, v3, 0
    v_bfe_u32 v3, v0, 3, 1
    v_lshlrev_b32 v3, 2, v3
    v_xor_b32 v2, v2, v3
    v_lshl_add_u32 v160, v2, 4, v160
    v_and_b32 v2, 1, v0
    v_lshl_add_u32 v160, v2, 3, v160
    s_lshl_b32 s73, s68, 14
    v_add_u32 v160, s73, v160
    v_xor_b32 v161, 64, v160
    v_and_b32 v2, 31, v0
    v_bfe_u32 v3, v0, 1, 3
    v_lshrrev_b32 v7, 5, v0
    v_xor_b32 v3, v3, v7
    v_lshlrev_b32 v108, 7, v2
    v_lshl_add_u32 v108, v3, 4, v108
    v_add_u32 v108, 0x10000, v108
    v_xor_b32 v109, 32, v108
    v_xor_b32 v110, 64, v108
    v_xor_b32 v111, 96, v108
    v_mov_b32 v76, 0
    v_mov_b32 v77, 0
    v_mov_b32 v78, 0
    v_mov_b32 v79, 0
    v_mov_b32 v80, 0
    v_mov_b32 v81, 0
    v_mov_b32 v82, 0
    v_mov_b32 v83, 0
    v_mov_b32 v84, 0
    v_mov_b32 v85, 0
    v_mov_b32 v86, 0
    v_mov_b32 v87, 0
    v_mov_b32 v88, 0
    v_mov_b32 v89, 0
    v_mov_b32 v90, 0
    v_mov_b32 v91, 0
    v_mov_b32 v92, 0
    v_mov_b32 v93, 0
    v_mov_b32 v94, 0
    v_mov_b32 v95, 0
    v_mov_b32 v96, 0
    v_mov_b32 v97, 0
    v_mov_b32 v98, 0
    v_mov_b32 v99, 0
    v_mov_b32 v100, 0
    v_mov_b32 v101, 0
    v_mov_b32 v102, 0
    v_mov_b32 v103, 0
    v_mov_b32 v104, 0
    v_mov_b32 v105, 0
    v_mov_b32 v106, 0
    v_mov_b32 v107, 0
    v_and_b32 v2, 27, v0
    v_cmp_eq_u32 vcc, 16, v2
    v_mov_b32 v2, 0x3f803f80
    s_nop 0
    v_cndmask_b32 v28, 0, v2, vcc
    v_mov_b32 v29, v28
    v_mov_b32 v30, v28
    v_mov_b32 v31, v28
    v_mov_b32 v32, v28
    v_mov_b32 v33, v28
    v_mov_b32 v34, v28
    v_mov_b32 v35, v28
    v_mov_b32 v36, v28
    v_mov_b32 v37, v28
    v_mov_b32 v38, v28
    v_mov_b32 v39, v28
    v_mov_b32 v40, v28
    v_mov_b32 v41, v28
    v_mov_b32 v42, v28
    v_mov_b32 v43, v28
    v_mov_b32 v8, 0xdddddddd
    s_lshr_b32 s73, s68, 2
    s_lshl_b32 s73, s73, 11
    v_add_u32 v9, s73, v6
    v_lshlrev_b32 v7, 8, v7
    v_lshl_add_u32 v7, v5, 4, v7
    v_add_u32 v10, s73, v7
    s_lshl_b32 s78, s70, 5
    s_add_u32 s78, s78, s69
    s_lshl_b32 s78, s78, 7
    s_lshl_b32 s73, s68, 2
    s_add_u32 s78, s78, s73
    s_add_u32 s78, s78, 0x4000
    s_cmp_lt_u32 s68, 4
    s_cbranch_scc1 L_A_GQ
    s_waitcnt lgkmcnt(0)
    s_mul_i32 s71, s71, 0x9E3779B1
    s_add_u32 s71, s71, 0x7F4A7C15
    v_lshrrev_b32 v4, 4, v0
    v_lshlrev_b32 v4, 8, v4
    v_lshl_add_u32 v4, v5, 3, v4
    s_add_u32 s72, s72, 131072
    v_add_u32 v4, s72, v4
    s_lshl_b32 s73, s75, 10
    s_add_u32 s73, s73, 155648
    v_add_u32 v2, s73, v6
    s_lshl_b32 s73, s75, 8
    s_add_u32 s73, s73, 159744
    v_add_u32 v3, s73, v11
    s_waitcnt vmcnt(0)
    ds_read_b64_tr_b16 v[44:45], v4 offset:0
    ds_read_b64_tr_b16 v[46:47], v4 offset:128
    ds_read_b64_tr_b16 v[48:49], v4 offset:1024
    ds_read_b64_tr_b16 v[50:51], v4 offset:1152
    ds_read_b64_tr_b16 v[52:53], v4 offset:2048
    ds_read_b64_tr_b16 v[54:55], v4 offset:2176
    ds_read_b64_tr_b16 v[56:57], v4 offset:3072
    ds_read_b64_tr_b16 v[58:59], v4 offset:3200
    v_mfma_f32_16x16x32_bf16 v[64:67], v[132:135], v[116:119], 0
    v_mfma_f32_16x16x32_bf16 v[64:67], v[136:139], v[120:123], v[64:67]
    v_mfma_f32_16x16x32_bf16 v[64:67], v[140:143], v[124:127], v[64:67]
    v_mfma_f32_16x16x32_bf16 v[64:67], v[144:147], v[128:131], v[64:67]
    s_cmp_lt_u32 s70, 4
    s_waitcnt lgkmcnt(0)
    s_cbranch_scc0 L_A_VJOB
    v_mfma_f32_16x16x32_bf16 v[60:63], v[44:47], v[116:119], 0
    v_mfma_f32_16x16x32_bf16 v[60:63], v[48:51], v[120:123], v[60:63]
    v_mfma_f32_16x16x32_bf16 v[60:63], v[52:55], v[124:127], v[60:63]
    v_mfma_f32_16x16x32_bf16 v[60:63], v[56:59], v[128:131], v[60:63]
    s_branch L_A_KVJ
L_A_VJOB:
    v_mfma_f32_16x16x32_bf16 v[60:63], v[116:119], v[44:47], 0
    v_mfma_f32_16x16x32_bf16 v[60:63], v[120:123], v[48:51], v[60:63]
    v_mfma_f32_16x16x32_bf16 v[60:63], v[124:127], v[52:55], v[60:63]
    v_mfma_f32_16x16x32_bf16 v[60:63], v[128:131], v[56:59], v[60:63]
L_A_KVJ:
    s_nop 0
    ds_write_b32 v3, v64
    s_nop 5
    ds_write_b128 v2, v[60:63]
    s_waitcnt lgkmcnt(0)
    s_lshl_b32 s72, s75, 2
    s_add_u32 s72, s72, 163328
    v_mov_b32 v2, s72
    v_mov_b32 v3, 1
    s_mov_b64 exec, 1
    ds_write_b32 v2, v3
    s_mov_b64 exec, -1
    s_cmp_eq_u32 s68, 7
    s_cbranch_scc0 L_A_BS
    v_and_b32 v2, 3, v0
    v_lshlrev_b32 v2, 2, v2
    v_add_u32 v2, 163328, v2
    s_mov_b32 s84, 400000
tw_41:
    ds_read_b32 v3, v2
    s_waitcnt lgkmcnt(0)
    v_cmp_ne_u32 vcc, 1, v3
    s_cbranch_vccz twd_42
    s_sub_u32 s84, s84, 1
    s_cbranch_scc1 twd_42
    s_branch tw_41
twd_42:
    v_add_u32 v3, 155648, v6
    v_add_u32 v4, 159744, v11
    ds_read_b128 v[116:119], v3 offset:0
    ds_read_b128 v[120:123], v3 offset:1024
    ds_read_b128 v[124:127], v3 offset:2048
    ds_read_b128 v[128:131], v3 offset:3072
    ds_read2st64_b32 v[148:149], v4 offset0:0 offset1:1
    ds_read2st64_b32 v[150:151], v4 offset0:2 offset1:3
    s_lshl_b32 s75, s69, 1
    s_lshr_b32 s76, s81, 1
    s_add_u32 s75, s75, s76
    s_lshl_b32 s75, s75, 11
    s_add_u32 s75, s75, 0x20000
    s_and_b32 s76, s81, 1
    s_cmp_lt_u32 s70, 4
    s_cselect_b32 s77, 9, 3
    s_cselect_b32 s79, 3, 8
    s_cselect_b32 s73, 8, 9
    s_cselect_b32 s72, 0, 0x400
    s_lshl_b32 s76, s76, s73
    s_add_u32 s75, s75, s76
    s_add_u32 s75, s75, s72
    v_bfe_u32 v3, v0, 4, 1
    v_lshrrev_b32 v4, 5, v0
    v_lshlrev_b32 v5, 4, v5
    v_lshl_add_u32 v5, v3, s77, v5
    v_lshl_add_u32 v5, v4, s79, v5
    s_lshl_b32 s79, s69, 3
    s_add_u32 s79, s79, s70
    s_and_b32 s73, s79, 3
    s_lshr_b32 s79, s79, 2
    s_lshl_b32 s79, s79, 7
    s_lshl_b32 s73, s73, 2
    s_add_u32 s79, s79, s73
    s_add_u32 s79, s79, 0x1000
    s_waitcnt lgkmcnt(2)
    v_add_f32 v116, v116, v124
    v_add_f32 v117, v117, v125
    v_add_f32 v118, v118, v126
    v_add_f32 v119, v119, v127
    v_add_f32 v120, v120, v128
    v_add_f32 v121, v121, v129
    v_add_f32 v122, v122, v130
    v_add_f32 v123, v123, v131
    v_add_f32 v116, v116, v120
    v_add_f32 v117, v117, v121
    v_add_f32 v118, v118, v122
    v_add_f32 v119, v119, v123
    v_cvt_pk_bf16_f32 v116, v116, v117
    v_cvt_pk_bf16_f32 v117, v118, v119
    buffer_store_dwordx2 v[116:117], v5, s[60:63], s75 offen sc1
    s_cmp_lt_u32 s70, 4
    s_waitcnt lgkmcnt(0)
    s_cbranch_scc0 L_A_SF
    v_add_f32 v148, v148, v150
    v_add_f32 v149, v149, v151
    v_add_f32 v148, v148, v149
    s_mov_b32 s72, 0xbfb8aa3b
    v_mul_f32 v148, s72, v148
    v_exp_f32 v148, v148
    s_lshl_b32 s72, s69, 2
    s_add_u32 s72, s72, s81
    v_add_f32 v148, 1.0, v148
    v_rcp_f32 v148, v148
    s_lshl_b32 s72, s72, 6
    s_add_u32 s72, s72, 0x1c000
    s_mov_b64 exec, 0xffff
    buffer_store_dword v148, v11, s[60:63], s72 offen sc1
    s_mov_b64 exec, -1
L_A_SF:
    s_waitcnt vmcnt(0)
    v_mov_b32 v2, s71
    s_mov_b64 exec, 1
    buffer_store_dword v2, off, s[60:63], s79 sc1
    s_mov_b64 exec, -1
L_A_BS:
    s_cmp_eq_u32 s68, 6
    s_cbranch_scc0 L_A_B8
    v_lshlrev_b32 v16, 7, v0
    v_lshrrev_b32 v17, 0, v0
    v_lshlrev_b32 v17, 7, v17
    v_and_b32 v18, 0, v0
    v_lshl_add_u32 v17, v18, 4, v17
    v_add_u32 v17, 0x1000, v17
    v_mov_b32 v2, s71
    ds_write_b32 v1, v2 offset:32372
    v_and_b32 v2, 3, v0
    v_lshlrev_b32 v2, 2, v2
    v_add_u32 v2, 163328, v2
    s_mov_b32 s84, 400000
tw_43:
    ds_read_b32 v3, v2
    s_waitcnt lgkmcnt(0)
    v_cmp_ne_u32 vcc, 1, v3
    s_cbranch_vccz twd_44
    s_sub_u32 s84, s84, 1
    s_cbranch_scc1 twd_44
    s_branch tw_43
twd_44:
    v_and_b32 v2, 0, v0
    v_lshlrev_b32 v2, 2, v2
    v_add_u32 v2, 163376, v2
    s_mov_b32 s84, 400000
tw_45:
    ds_read_b32 v3, v2
    s_waitcnt lgkmcnt(0)
    v_cmp_ne_u32 vcc, 1, v3
    s_cbranch_vccz twd_46
    s_sub_u32 s84, s84, 1
    s_cbranch_scc1 twd_46
    s_sleep 2
    s_branch tw_45
twd_46:
    s_mov_b32 s84, 400000
L_A_PL:
    buffer_load_dwordx4 v[12:15], v17, s[60:63], 0 offen sc1
    s_waitcnt vmcnt(0)
    v_xor_b32 v12, s71, v12
    v_xor_b32 v13, s71, v13
    v_xor_b32 v14, s71, v14
    v_xor_b32 v15, s71, v15
    v_or3_b32 v12, v12, v13, v14
    v_or_b32 v12, v12, v15
    v_cmp_ne_u32 vcc, 0, v12
    s_cbranch_vccz L_A_PLD
    s_sub_u32 s84, s84, 1
    s_cbranch_scc1 L_A_PLD
    s_mov_b64 exec, vcc
    s_sleep 16
    s_branch L_A_PL
L_A_PLD:
    s_mov_b64 exec, -1
    s_lshr_b32 s77, s2, 3
    s_lshl_b32 s77, s77, 12
    s_add_u32 s77, s77, 0x20000
    s_mov_b32 exec_hi, 0
    buffer_load_dword v117, v16, s[60:63], s77 offen sc1
    s_mov_b64 exec, -1
    v_mov_b32 v2, 163380
    v_mov_b32 v3, 1
    s_mov_b64 exec, 1
    ds_write_b32 v2, v3
    s_mov_b64 exec, -1
    s_lshr_b32 s77, s2, 3
    s_and_b32 s77, s77, 3
    s_lshl_b32 s77, s77, 14
    s_add_u32 s77, s77, 0x20000
    s_mov_b32 m0, 131072
    s_add_u32 s76, s77, 0
    buffer_load_dwordx4 v6, s[60:63], s76 offen offset:0 sc1 lds
    buffer_load_dwordx4 v6, s[60:63], s76 offen offset:1024 sc1 lds
    buffer_load_dwordx4 v6, s[60:63], s76 offen offset:2048 sc1 lds
    buffer_load_dwordx4 v6, s[60:63], s76 offen offset:3072 sc1 lds
    s_mov_b32 m0, 135168
    s_add_u32 s76, s77, 4096
    buffer_load_dwordx4 v6, s[60:63], s76 offen offset:0 sc1 lds
    buffer_load_dwordx4 v6, s[60:63], s76 offen offset:1024 sc1 lds
    buffer_load_dwordx4 v6, s[60:63], s76 offen offset:2048 sc1 lds
    buffer_load_dwordx4 v6, s[60:63], s76 offen offset:3072 sc1 lds
    s_mov_b32 m0, 139264
    s_add_u32 s76, s77, 8192
    buffer_load_dwordx4 v6, s[60:63], s76 offen offset:0 sc1 lds
    buffer_load_dwordx4 v6, s[60:63], s76 offen offset:1024 sc1 lds
    buffer_load_dwordx4 v6, s[60:63], s76 offen offset:2048 sc1 lds
    buffer_load_dwordx4 v6, s[60:63], s76 offen offset:3072 sc1 lds
    s_mov_b32 m0, 143360
    s_add_u32 s76, s77, 12288
    buffer_load_dwordx4 v6, s[60:63], s76 offen offset:0 sc1 lds
    buffer_load_dwordx4 v6, s[60:63], s76 offen offset:1024 sc1 lds
    buffer_load_dwordx4 v6, s[60:63], s76 offen offset:2048 sc1 lds
    buffer_load_dwordx4 v6, s[60:63], s76 offen offset:3072 sc1 lds
    s_waitcnt vmcnt(0)
    v_mov_b32 v2, 163424
    v_mov_b32 v3, 1
    s_mov_b64 exec, 1
    ds_write_b32 v2, v3
    s_mov_b64 exec, -1
    s_cmp_eq_u32 s2, 0
    s_cbranch_scc0 L_A_B8
    s_mov_b32 s72, 0
    v_mov_b32 v2, s71
    s_mov_b64 exec, 1
    buffer_store_dword v2, off, s[60:63], s72 sc1
    s_mov_b64 exec, -1
    s_branch L_A_B8
L_A_GQ:
    s_sub_u32 s76, s68, 1
    s_cmp_eq_u32 s68, 1
    s_cselect_b32 s76, 3, s76
    s_lshr_b32 s77, s2, 3
    s_add_u32 s77, s77, s76
    s_and_b32 s77, s77, 3
    s_lshl_b32 s77, s77, 14
    s_add_u32 s77, s77, 0x20000
    v_and_b32 v2, 3, v0
    v_lshlrev_b32 v2, 2, v2
    v_add_u32 v2, 163408, v2
    s_mov_b32 s84, 400000
tw_47:
    ds_read_b32 v3, v2
    s_waitcnt lgkmcnt(0)
    v_cmp_ne_u32 vcc, 1, v3
    s_cbranch_vccz twd_48
    s_sub_u32 s84, s84, 1
    s_cbranch_scc1 twd_48
    s_branch tw_47
twd_48:
    s_waitcnt vmcnt(14)
    ds_read_b64_tr_b16 v[12:13], v160 offset:0
    ds_read_b64_tr_b16 v[14:15], v160 offset:512
    ds_read_b64_tr_b16 v[16:17], v161 offset:0
    ds_read_b64_tr_b16 v[18:19], v161 offset:512
    ds_read_b128 v[20:23], v108 offset:0
    ds_read_b128 v[24:27], v108 offset:4096
    s_waitcnt vmcnt(12)
    ds_read_b64_tr_b16 v[112:113], v160 offset:2048
    ds_read_b64_tr_b16 v[114:115], v160 offset:2560
    ds_read_b64_tr_b16 v[116:117], v161 offset:2048
    ds_read_b64_tr_b16 v[118:119], v161 offset:2560
    ds_read_b128 v[120:123], v109 offset:0
    ds_read_b128 v[124:127], v109 offset:4096
    s_cmp_eq_u32 s68, 3
    s_cbranch_scc1 L_A_GV
    s_waitcnt vmcnt(10) lgkmcnt(6)
    v_mfma_f32_32x32x16_bf16 v[44:59], v[12:15], v[20:23], 0
    ds_read_b64_tr_b16 v[92:93], v160 offset:4096
    ds_read_b64_tr_b16 v[94:95], v160 offset:4608
    s_add_u32 m0, s79, 0
    s_add_u32 s75, s83, 2
    s_and_b32 s75, s75, 7
    s_lshl_b32 s75, s75, 2
    s_mul_i32 s75, s75, s82
    v_mfma_f32_32x32x16_bf16 v[60:75], v[12:15], v[24:27], 0
    ds_read_b64_tr_b16 v[96:97], v161 offset:4096
    ds_read_b64_tr_b16 v[98:99], v161 offset:4608
    buffer_load_dwordx4 v162, s[40:43], s75 offen lds
    v_mfma_f32_32x32x16_bf16 v[128:143], v[16:19], v[20:23], 0
    ds_read_b128 v[100:103], v110 offset:0
    ds_read_b128 v[104:107], v110 offset:4096
    v_mfma_f32_32x32x16_bf16 v[144:159], v[16:19], v[24:27], 0
    buffer_load_dwordx4 v163, s[40:43], s75 offen offset:1024 lds
    s_waitcnt vmcnt(10) lgkmcnt(6)
    v_mfma_f32_32x32x16_bf16 v[44:59], v[112:115], v[120:123], v[44:59]
    ds_read_b64_tr_b16 v[12:13], v160 offset:6144
    ds_read_b64_tr_b16 v[14:15], v160 offset:6656
    s_add_u32 m0, s79, 2048
    s_add_u32 s75, s75, s82
    v_mfma_f32_32x32x16_bf16 v[60:75], v[112:115], v[124:127], v[60:75]
    ds_read_b64_tr_b16 v[16:17], v161 offset:6144
    ds_read_b64_tr_b16 v[18:19], v161 offset:6656
    buffer_load_dwordx4 v162, s[40:43], s75 offen lds
    v_mfma_f32_32x32x16_bf16 v[128:143], v[116:119], v[120:123], v[128:143]
    ds_read_b128 v[20:23], v111 offset:0
    ds_read_b128 v[24:27], v111 offset:4096
    v_mfma_f32_32x32x16_bf16 v[144:159], v[116:119], v[124:127], v[144:159]
    buffer_load_dwordx4 v163, s[40:43], s75 offen offset:1024 lds
    s_waitcnt lgkmcnt(0)
    v_and_b32 v2, 3, v0
    v_lshlrev_b32 v2, 2, v2
    v_add_u32 v2, 163344, v2
    s_mov_b32 s84, 400000
tw_49:
    ds_read_b32 v3, v2
    s_waitcnt lgkmcnt(0)
    v_cmp_ne_u32 vcc, 1, v3
    s_cbranch_vccz twd_50
    s_sub_u32 s84, s84, 1
    s_cbranch_scc1 twd_50
    s_branch tw_49
twd_50:
    s_waitcnt vmcnt(10) lgkmcnt(6)
    v_mfma_f32_32x32x16_bf16 v[44:59], v[92:95], v[100:103], v[44:59]
    ds_read_b64_tr_b16 v[112:113], v160 offset:8192
    ds_read_b64_tr_b16 v[114:115], v160 offset:8704
    s_add_u32 m0, s79, 4096
    s_add_u32 s75, s75, s82
    v_mfma_f32_32x32x16_bf16 v[60:75], v[92:95], v[104:107], v[60:75]
    ds_read_b64_tr_b16 v[116:117], v161 offset:8192
    ds_read_b64_tr_b16 v[118:119], v161 offset:8704
    buffer_load_dwordx4 v162, s[40:43], s75 offen lds
    v_mfma_f32_32x32x16_bf16 v[128:143], v[96:99], v[100:103], v[128:143]
    ds_read_b128 v[120:123], v108 offset:8192
    ds_read_b128 v[124:127], v108 offset:12288
    v_mfma_f32_32x32x16_bf16 v[144:159], v[96:99], v[104:107], v[144:159]
    buffer_load_dwordx4 v163, s[40:43], s75 offen offset:1024 lds
    s_waitcnt vmcnt(10) lgkmcnt(6)
    v_mfma_f32_32x32x16_bf16 v[44:59], v[12:15], v[20:23], v[44:59]
    ds_read_b64_tr_b16 v[92:93], v160 offset:10240
    ds_read_b64_tr_b16 v[94:95], v160 offset:10752
    s_add_u32 m0, s79, 6144
    s_add_u32 s75, s75, s82
    v_mfma_f32_32x32x16_bf16 v[60:75], v[12:15], v[24:27], v[60:75]
    ds_read_b64_tr_b16 v[96:97], v161 offset:10240
    ds_read_b64_tr_b16 v[98:99], v161 offset:10752
    buffer_load_dwordx4 v162, s[40:43], s75 offen lds
    v_mfma_f32_32x32x16_bf16 v[128:143], v[16:19], v[20:23], v[128:143]
    ds_read_b128 v[100:103], v109 offset:8192
    ds_read_b128 v[104:107], v109 offset:12288
    v_mfma_f32_32x32x16_bf16 v[144:159], v[16:19], v[24:27], v[144:159]
    buffer_load_dwordx4 v163, s[40:43], s75 offen offset:1024 lds
    s_waitcnt vmcnt(10) lgkmcnt(6)
    v_mfma_f32_32x32x16_bf16 v[44:59], v[112:115], v[120:123], v[44:59]
    ds_read_b64_tr_b16 v[12:13], v160 offset:12288
    ds_read_b64_tr_b16 v[14:15], v160 offset:12800
    s_add_u32 m0, s79, 8192
    s_add_u32 s75, s83, 3
    s_and_b32 s75, s75, 7
    s_lshl_b32 s75, s75, 2
    s_mul_i32 s75, s75, s82
    v_mfma_f32_32x32x16_bf16 v[60:75], v[112:115], v[124:127], v[60:75]
    ds_read_b64_tr_b16 v[16:17], v161 offset:12288
    ds_read_b64_tr_b16 v[18:19], v161 offset:12800
    buffer_load_dwordx4 v162, s[40:43], s75 offen lds
    v_mfma_f32_32x32x16_bf16 v[128:143], v[116:119], v[120:123], v[128:143]
    ds_read_b128 v[20:23], v110 offset:8192
    ds_read_b128 v[24:27], v110 offset:12288
    v_mfma_f32_32x32x16_bf16 v[144:159], v[116:119], v[124:127], v[144:159]
    buffer_load_dwordx4 v163, s[40:43], s75 offen offset:1024 lds
    s_waitcnt vmcnt(10) lgkmcnt(6)
    v_mfma_f32_32x32x16_bf16 v[44:59], v[92:95], v[100:103], v[44:59]
    ds_read_b64_tr_b16 v[112:113], v160 offset:14336
    ds_read_b64_tr_b16 v[114:115], v160 offset:14848
    s_add_u32 m0, s79, 10240
    s_add_u32 s75, s75, s82
    v_mfma_f32_32x32x16_bf16 v[60:75], v[92:95], v[104:107], v[60:75]
    ds_read_b64_tr_b16 v[116:117], v161 offset:14336
    ds_read_b64_tr_b16 v[118:119], v161 offset:14848
    buffer_load_dwordx4 v162, s[40:43], s75 offen lds
    v_mfma_f32_32x32x16_bf16 v[128:143], v[96:99], v[100:103], v[128:143]
    ds_read_b128 v[120:123], v111 offset:8192
    ds_read_b128 v[124:127], v111 offset:12288
    v_mfma_f32_32x32x16_bf16 v[144:159], v[96:99], v[104:107], v[144:159]
    buffer_load_dwordx4 v163, s[40:43], s75 offen offset:1024 lds
    s_waitcnt vmcnt(10) lgkmcnt(6)
    v_mfma_f32_32x32x16_bf16 v[44:59], v[12:15], v[20:23], v[44:59]
    ds_read_b64_tr_b16 v[92:93], v160 offset:0
    ds_read_b64_tr_b16 v[94:95], v160 offset:512
    s_add_u32 m0, s79, 12288
    s_add_u32 s75, s75, s82
    v_mfma_f32_32x32x16_bf16 v[60:75], v[12:15], v[24:27], v[60:75]
    ds_read_b64_tr_b16 v[96:97], v161 offset:0
    ds_read_b64_tr_b16 v[98:99], v161 offset:512
    buffer_load_dwordx4 v162, s[40:43], s75 offen lds
    v_mfma_f32_32x32x16_bf16 v[128:143], v[16:19], v[20:23], v[128:143]
    ds_read_b128 v[100:103], v108 offset:16384
    ds_read_b128 v[104:107], v108 offset:20480
    v_mfma_f32_32x32x16_bf16 v[144:159], v[16:19], v[24:27], v[144:159]
    buffer_load_dwordx4 v163, s[40:43], s75 offen offset:1024 lds
    s_waitcnt vmcnt(10) lgkmcnt(6)
    v_mfma_f32_32x32x16_bf16 v[44:59], v[112:115], v[120:123], v[44:59]
    ds_read_b64_tr_b16 v[12:13], v160 offset:2048
    ds_read_b64_tr_b16 v[14:15], v160 offset:2560
    s_add_u32 m0, s79, 14336
    s_add_u32 s75, s75, s82
    v_mfma_f32_32x32x16_bf16 v[60:75], v[112:115], v[124:127], v[60:75]
    ds_read_b64_tr_b16 v[16:17], v161 offset:2048
    ds_read_b64_tr_b16 v[18:19], v161 offset:2560
    buffer_load_dwordx4 v162, s[40:43], s75 offen lds
    v_mfma_f32_32x32x16_bf16 v[128:143], v[116:119], v[120:123], v[128:143]
    ds_read_b128 v[20:23], v109 offset:16384
    ds_read_b128 v[24:27], v109 offset:20480
    v_mfma_f32_32x32x16_bf16 v[144:159], v[116:119], v[124:127], v[144:159]
    buffer_load_dwordx4 v163, s[40:43], s75 offen offset:1024 lds
    s_waitcnt vmcnt(10) lgkmcnt(6)
    v_mfma_f32_32x32x16_bf16 v[44:59], v[92:95], v[100:103], v[44:59]
    ds_read_b64_tr_b16 v[112:113], v160 offset:4096
    ds_read_b64_tr_b16 v[114:115], v160 offset:4608
    s_add_u32 m0, s79, 0
    s_add_u32 s75, s83, 4
    s_and_b32 s75, s75, 7
    s_lshl_b32 s75, s75, 2
    s_mul_i32 s75, s75, s82
    v_mfma_f32_32x32x16_bf16 v[60:75], v[92:95], v[104:107], v[60:75]
    ds_read_b64_tr_b16 v[116:117], v161 offset:4096
    ds_read_b64_tr_b16 v[118:119], v161 offset:4608
    buffer_load_dwordx4 v162, s[40:43], s75 offen lds
    v_mfma_f32_32x32x16_bf16 v[128:143], v[96:99], v[100:103], v[128:143]
    ds_read_b128 v[120:123], v110 offset:16384
    ds_read_b128 v[124:127], v110 offset:20480
    v_mfma_f32_32x32x16_bf16 v[144:159], v[96:99], v[104:107], v[144:159]
    buffer_load_dwordx4 v163, s[40:43], s75 offen offset:1024 lds
    s_waitcnt vmcnt(10) lgkmcnt(6)
    v_mfma_f32_32x32x16_bf16 v[44:59], v[12:15], v[20:23], v[44:59]
    ds_read_b64_tr_b16 v[92:93], v160 offset:6144
    ds_read_b64_tr_b16 v[94:95], v160 offset:6656
    s_add_u32 m0, s79, 2048
    s_add_u32 s75, s75, s82
    v_mfma_f32_32x32x16_bf16 v[60:75], v[12:15], v[24:27], v[60:75]
    ds_read_b64_tr_b16 v[96:97], v161 offset:6144
    ds_read_b64_tr_b16 v[98:99], v161 offset:6656
    buffer_load_dwordx4 v162, s[40:43], s75 offen lds
    v_mfma_f32_32x32x16_bf16 v[128:143], v[16:19], v[20:23], v[128:143]
    ds_read_b128 v[100:103], v111 offset:16384
    ds_read_b128 v[104:107], v111 offset:20480
    v_mfma_f32_32x32x16_bf16 v[144:159], v[16:19], v[24:27], v[144:159]
    buffer_load_dwordx4 v163, s[40:43], s75 offen offset:1024 lds
    s_waitcnt vmcnt(10) lgkmcnt(6)
    v_mfma_f32_32x32x16_bf16 v[44:59], v[112:115], v[120:123], v[44:59]
    ds_read_b64_tr_b16 v[12:13], v160 offset:8192
    ds_read_b64_tr_b16 v[14:15], v160 offset:8704
    s_add_u32 m0, s79, 4096
    s_add_u32 s75, s75, s82
    v_mfma_f32_32x32x16_bf16 v[60:75], v[112:115], v[124:127], v[60:75]
    ds_read_b64_tr_b16 v[16:17], v161 offset:8192
    ds_read_b64_tr_b16 v[18:19], v161 offset:8704
    buffer_load_dwordx4 v162, s[40:43], s75 offen lds
    v_mfma_f32_32x32x16_bf16 v[128:143], v[116:119], v[120:123], v[128:143]
    ds_read_b128 v[20:23], v108 offset:24576
    ds_read_b128 v[24:27], v108 offset:28672
    v_mfma_f32_32x32x16_bf16 v[144:159], v[116:119], v[124:127], v[144:159]
    buffer_load_dwordx4 v163, s[40:43], s75 offen offset:1024 lds
    s_waitcnt vmcnt(10) lgkmcnt(6)
    v_mfma_f32_32x32x16_bf16 v[44:59], v[92:95], v[100:103], v[44:59]
    ds_read_b64_tr_b16 v[112:113], v160 offset:10240
    ds_read_b64_tr_b16 v[114:115], v160 offset:10752
    s_add_u32 m0, s79, 6144
    s_add_u32 s75, s75, s82
    v_mfma_f32_32x32x16_bf16 v[60:75], v[92:95], v[104:107], v[60:75]
    ds_read_b64_tr_b16 v[116:117], v161 offset:10240
    ds_read_b64_tr_b16 v[118:119], v161 offset:10752
    buffer_load_dwordx4 v162, s[40:43], s75 offen lds
    v_mfma_f32_32x32x16_bf16 v[128:143], v[96:99], v[100:103], v[128:143]
    ds_read_b128 v[120:123], v109 offset:24576
    ds_read_b128 v[124:127], v109 offset:28672
    v_mfma_f32_32x32x16_bf16 v[144:159], v[96:99], v[104:107], v[144:159]
    buffer_load_dwordx4 v163, s[40:43], s75 offen offset:1024 lds
    s_waitcnt vmcnt(10) lgkmcnt(6)
    v_mfma_f32_32x32x16_bf16 v[44:59], v[12:15], v[20:23], v[44:59]
    ds_read_b64_tr_b16 v[92:93], v160 offset:12288
    ds_read_b64_tr_b16 v[94:95], v160 offset:12800
    s_add_u32 m0, s79, 8192
    s_add_u32 s75, s83, 5
    s_and_b32 s75, s75, 7
    s_lshl_b32 s75, s75, 2
    s_mul_i32 s75, s75, s82
    v_mfma_f32_32x32x16_bf16 v[60:75], v[12:15], v[24:27], v[60:75]
    ds_read_b64_tr_b16 v[96:97], v161 offset:12288
    ds_read_b64_tr_b16 v[98:99], v161 offset:12800
    buffer_load_dwordx4 v162, s[40:43], s75 offen lds
    v_mfma_f32_32x32x16_bf16 v[128:143], v[16:19], v[20:23], v[128:143]
    ds_read_b128 v[100:103], v110 offset:24576
    ds_read_b128 v[104:107], v110 offset:28672
    v_mfma_f32_32x32x16_bf16 v[144:159], v[16:19], v[24:27], v[144:159]
    buffer_load_dwordx4 v163, s[40:43], s75 offen offset:1024 lds
    s_waitcnt vmcnt(10) lgkmcnt(6)
    v_mfma_f32_32x32x16_bf16 v[44:59], v[112:115], v[120:123], v[44:59]
    ds_read_b64_tr_b16 v[12:13], v160 offset:14336
    ds_read_b64_tr_b16 v[14:15], v160 offset:14848
    s_add_u32 m0, s79, 10240
    s_add_u32 s75, s75, s82
    v_mfma_f32_32x32x16_bf16 v[60:75], v[112:115], v[124:127], v[60:75]
    ds_read_b64_tr_b16 v[16:17], v161 offset:14336
    ds_read_b64_tr_b16 v[18:19], v161 offset:14848
    buffer_load_dwordx4 v162, s[40:43], s75 offen lds
    v_mfma_f32_32x32x16_bf16 v[128:143], v[116:119], v[120:123], v[128:143]
    ds_read_b128 v[20:23], v111 offset:24576
    ds_read_b128 v[24:27], v111 offset:28672
    v_mfma_f32_32x32x16_bf16 v[144:159], v[116:119], v[124:127], v[144:159]
    buffer_load_dwordx4 v163, s[40:43], s75 offen offset:1024 lds
    s_waitcnt lgkmcnt(0)
    v_and_b32 v2, 3, v0
    v_lshlrev_b32 v2, 2, v2
    v_add_u32 v2, 163360, v2
    s_mov_b32 s84, 400000
tw_51:
    ds_read_b32 v3, v2
    s_waitcnt lgkmcnt(0)
    v_cmp_ne_u32 vcc, 1, v3
    s_cbranch_vccz twd_52
    s_sub_u32 s84, s84, 1
    s_cbranch_scc1 twd_52
    s_branch tw_51
twd_52:
    s_waitcnt vmcnt(10) lgkmcnt(6)
    v_mfma_f32_32x32x16_bf16 v[44:59], v[92:95], v[100:103], v[44:59]
    ds_read_b64_tr_b16 v[112:113], v160 offset:0
    ds_read_b64_tr_b16 v[114:115], v160 offset:512
    s_add_u32 m0, s79, 12288
    s_add_u32 s75, s75, s82
    v_mfma_f32_32x32x16_bf16 v[60:75], v[92:95], v[104:107], v[60:75]
    ds_read_b64_tr_b16 v[116:117], v161 offset:0
    ds_read_b64_tr_b16 v[118:119], v161 offset:512
    buffer_load_dwordx4 v162, s[40:43], s75 offen lds
    v_mfma_f32_32x32x16_bf16 v[128:143], v[96:99], v[100:103], v[128:143]
    ds_read_b128 v[120:123], v108 offset:32768
    ds_read_b128 v[124:127], v108 offset:36864
    v_mfma_f32_32x32x16_bf16 v[144:159], v[96:99], v[104:107], v[144:159]
    buffer_load_dwordx4 v163, s[40:43], s75 offen offset:1024 lds
    s_waitcnt vmcnt(10) lgkmcnt(6)
    v_mfma_f32_32x32x16_bf16 v[44:59], v[12:15], v[20:23], v[44:59]
    ds_read_b64_tr_b16 v[92:93], v160 offset:2048
    ds_read_b64_tr_b16 v[94:95], v160 offset:2560
    s_add_u32 m0, s79, 14336
    s_add_u32 s75, s75, s82
    v_mfma_f32_32x32x16_bf16 v[60:75], v[12:15], v[24:27], v[60:75]
    ds_read_b64_tr_b16 v[96:97], v161 offset:2048
    ds_read_b64_tr_b16 v[98:99], v161 offset:2560
    buffer_load_dwordx4 v162, s[40:43], s75 offen lds
    v_mfma_f32_32x32x16_bf16 v[128:143], v[16:19], v[20:23], v[128:143]
    ds_read_b128 v[100:103], v109 offset:32768
    ds_read_b128 v[104:107], v109 offset:36864
    v_mfma_f32_32x32x16_bf16 v[144:159], v[16:19], v[24:27], v[144:159]
    buffer_load_dwordx4 v163, s[40:43], s75 offen offset:1024 lds
    s_waitcnt vmcnt(10) lgkmcnt(6)
    v_mfma_f32_32x32x16_bf16 v[44:59], v[112:115], v[120:123], v[44:59]
    ds_read_b64_tr_b16 v[12:13], v160 offset:4096
    ds_read_b64_tr_b16 v[14:15], v160 offset:4608
    s_add_u32 m0, s79, 0
    s_add_u32 s75, s83, 6
    s_and_b32 s75, s75, 7
    s_lshl_b32 s75, s75, 2
    s_mul_i32 s75, s75, s82
    v_mfma_f32_32x32x16_bf16 v[60:75], v[112:115], v[124:127], v[60:75]
    ds_read_b64_tr_b16 v[16:17], v161 offset:4096
    ds_read_b64_tr_b16 v[18:19], v161 offset:4608
    buffer_load_dwordx4 v162, s[40:43], s75 offen lds
    v_mfma_f32_32x32x16_bf16 v[128:143], v[116:119], v[120:123], v[128:143]
    ds_read_b128 v[20:23], v110 offset:32768
    ds_read_b128 v[24:27], v110 offset:36864
    v_mfma_f32_32x32x16_bf16 v[144:159], v[116:119], v[124:127], v[144:159]
    buffer_load_dwordx4 v163, s[40:43], s75 offen offset:1024 lds
    s_waitcnt vmcnt(10) lgkmcnt(6)
    v_mfma_f32_32x32x16_bf16 v[44:59], v[92:95], v[100:103], v[44:59]
    ds_read_b64_tr_b16 v[112:113], v160 offset:6144
    ds_read_b64_tr_b16 v[114:115], v160 offset:6656
    s_add_u32 m0, s79, 2048
    s_add_u32 s75, s75, s82
    v_mfma_f32_32x32x16_bf16 v[60:75], v[92:95], v[104:107], v[60:75]
    ds_read_b64_tr_b16 v[116:117], v161 offset:6144
    ds_read_b64_tr_b16 v[118:119], v161 offset:6656
    buffer_load_dwordx4 v162, s[40:43], s75 offen lds
    v_mfma_f32_32x32x16_bf16 v[128:143], v[96:99], v[100:103], v[128:143]
    ds_read_b128 v[120:123], v111 offset:32768
    ds_read_b128 v[124:127], v111 offset:36864
    v_mfma_f32_32x32x16_bf16 v[144:159], v[96:99], v[104:107], v[144:159]
    buffer_load_dwordx4 v163, s[40:43], s75 offen offset:1024 lds
    s_waitcnt vmcnt(10) lgkmcnt(6)
    v_mfma_f32_32x32x16_bf16 v[44:59], v[12:15], v[20:23], v[44:59]
    ds_read_b64_tr_b16 v[92:93], v160 offset:8192
    ds_read_b64_tr_b16 v[94:95], v160 offset:8704
    s_add_u32 m0, s79, 4096
    s_add_u32 s75, s75, s82
    v_mfma_f32_32x32x16_bf16 v[60:75], v[12:15], v[24:27], v[60:75]
    ds_read_b64_tr_b16 v[96:97], v161 offset:8192
    ds_read_b64_tr_b16 v[98:99], v161 offset:8704
    buffer_load_dwordx4 v162, s[40:43], s75 offen lds
    v_mfma_f32_32x32x16_bf16 v[128:143], v[16:19], v[20:23], v[128:143]
    ds_read_b128 v[100:103], v108 offset:40960
    ds_read_b128 v[104:107], v108 offset:45056
    v_mfma_f32_32x32x16_bf16 v[144:159], v[16:19], v[24:27], v[144:159]
    buffer_load_dwordx4 v163, s[40:43], s75 offen offset:1024 lds
    s_waitcnt vmcnt(10) lgkmcnt(6)
    v_mfma_f32_32x32x16_bf16 v[44:59], v[112:115], v[120:123], v[44:59]
    ds_read_b64_tr_b16 v[12:13], v160 offset:10240
    ds_read_b64_tr_b16 v[14:15], v160 offset:10752
    s_add_u32 m0, s79, 6144
    s_add_u32 s75, s75, s82
    v_mfma_f32_32x32x16_bf16 v[60:75], v[112:115], v[124:127], v[60:75]
    ds_read_b64_tr_b16 v[16:17], v161 offset:10240
    ds_read_b64_tr_b16 v[18:19], v161 offset:10752
    buffer_load_dwordx4 v162, s[40:43], s75 offen lds
    v_mfma_f32_32x32x16_bf16 v[128:143], v[116:119], v[120:123], v[128:143]
    ds_read_b128 v[20:23], v109 offset:40960
    ds_read_b128 v[24:27], v109 offset:45056
    v_mfma_f32_32x32x16_bf16 v[144:159], v[116:119], v[124:127], v[144:159]
    buffer_load_dwordx4 v163, s[40:43], s75 offen offset:1024 lds
    s_waitcnt vmcnt(10) lgkmcnt(6)
    v_mfma_f32_32x32x16_bf16 v[44:59], v[92:95], v[100:103], v[44:59]
    ds_read_b64_tr_b16 v[112:113], v160 offset:12288
    ds_read_b64_tr_b16 v[114:115], v160 offset:12800
    s_add_u32 m0, s79, 8192
    s_add_u32 s75, s83, 7
    s_and_b32 s75, s75, 7
    s_lshl_b32 s75, s75, 2
    s_mul_i32 s75, s75, s82
    v_mfma_f32_32x32x16_bf16 v[60:75], v[92:95], v[104:107], v[60:75]
    ds_read_b64_tr_b16 v[116:117], v161 offset:12288
    ds_read_b64_tr_b16 v[118:119], v161 offset:12800
    buffer_load_dwordx4 v162, s[40:43], s75 offen lds
    v_mfma_f32_32x32x16_bf16 v[128:143], v[96:99], v[100:103], v[128:143]
    ds_read_b128 v[120:123], v110 offset:40960
    ds_read_b128 v[124:127], v110 offset:45056
    v_mfma_f32_32x32x16_bf16 v[144:159], v[96:99], v[104:107], v[144:159]
    buffer_load_dwordx4 v163, s[40:43], s75 offen offset:1024 lds
    s_waitcnt vmcnt(10) lgkmcnt(6)
    v_mfma_f32_32x32x16_bf16 v[44:59], v[12:15], v[20:23], v[44:59]
    ds_read_b64_tr_b16 v[92:93], v160 offset:14336
    ds_read_b64_tr_b16 v[94:95], v160 offset:14848
    s_add_u32 m0, s79, 10240
    s_add_u32 s75, s75, s82
    v_mfma_f32_32x32x16_bf16 v[60:75], v[12:15], v[24:27], v[60:75]
    ds_read_b64_tr_b16 v[96:97], v161 offset:14336
    ds_read_b64_tr_b16 v[98:99], v161 offset:14848
    buffer_load_dwordx4 v162, s[40:43], s75 offen lds
    v_mfma_f32_32x32x16_bf16 v[128:143], v[16:19], v[20:23], v[128:143]
    ds_read_b128 v[100:103], v111 offset:40960
    ds_read_b128 v[104:107], v111 offset:45056
    v_mfma_f32_32x32x16_bf16 v[144:159], v[16:19], v[24:27], v[144:159]
    buffer_load_dwordx4 v163, s[40:43], s75 offen offset:1024 lds
    s_waitcnt vmcnt(10) lgkmcnt(6)
    v_mfma_f32_32x32x16_bf16 v[44:59], v[112:115], v[120:123], v[44:59]
    ds_read_b64_tr_b16 v[12:13], v160 offset:0
    ds_read_b64_tr_b16 v[14:15], v160 offset:512
    s_add_u32 m0, s79, 12288
    s_add_u32 s75, s75, s82
    v_mfma_f32_32x32x16_bf16 v[60:75], v[112:115], v[124:127], v[60:75]
    ds_read_b64_tr_b16 v[16:17], v161 offset:0
    ds_read_b64_tr_b16 v[18:19], v161 offset:512
    buffer_load_dwordx4 v162, s[40:43], s75 offen lds
    v_mfma_f32_32x32x16_bf16 v[128:143], v[116:119], v[120:123], v[128:143]
    ds_read_b128 v[20:23], v108 offset:49152
    ds_read_b128 v[24:27], v108 offset:53248
    v_mfma_f32_32x32x16_bf16 v[144:159], v[116:119], v[124:127], v[144:159]
    buffer_load_dwordx4 v163, s[40:43], s75 offen offset:1024 lds
    s_waitcnt vmcnt(10) lgkmcnt(6)
    v_mfma_f32_32x32x16_bf16 v[44:59], v[92:95], v[100:103], v[44:59]
    ds_read_b64_tr_b16 v[112:113], v160 offset:2048
    ds_read_b64_tr_b16 v[114:115], v160 offset:2560
    s_add_u32 m0, s79, 14336
    s_add_u32 s75, s75, s82
    v_mfma_f32_32x32x16_bf16 v[60:75], v[92:95], v[104:107], v[60:75]
    ds_read_b64_tr_b16 v[116:117], v161 offset:2048
    ds_read_b64_tr_b16 v[118:119], v161 offset:2560
    buffer_load_dwordx4 v162, s[40:43], s75 offen lds
    v_mfma_f32_32x32x16_bf16 v[128:143], v[96:99], v[100:103], v[128:143]
    ds_read_b128 v[120:123], v109 offset:49152
    ds_read_b128 v[124:127], v109 offset:53248
    v_mfma_f32_32x32x16_bf16 v[144:159], v[96:99], v[104:107], v[144:159]
    buffer_load_dwordx4 v163, s[40:43], s75 offen offset:1024 lds
    s_cmp_eq_u32 s68, 0
    s_cbranch_scc1 L_A_G0
    v_and_b32 v2, 0, v0
    v_lshlrev_b32 v2, 2, v2
    v_add_u32 v2, 163380, v2
    ds_read_b32 v3, v2
    s_waitcnt lgkmcnt(0)
    v_cmp_ne_u32 vcc, 1, v3
    s_cbranch_vccz L_A_GK0
L_A_G0:
    s_waitcnt vmcnt(10) lgkmcnt(6)
    v_mfma_f32_32x32x16_bf16 v[44:59], v[12:15], v[20:23], v[44:59]
    ds_read_b64_tr_b16 v[92:93], v160 offset:4096
    ds_read_b64_tr_b16 v[94:95], v160 offset:4608
    v_mfma_f32_32x32x16_bf16 v[60:75], v[12:15], v[24:27], v[60:75]
    ds_read_b64_tr_b16 v[96:97], v161 offset:4096
    ds_read_b64_tr_b16 v[98:99], v161 offset:4608
    v_mfma_f32_32x32x16_bf16 v[128:143], v[16:19], v[20:23], v[128:143]
    ds_read_b128 v[100:103], v110 offset:49152
    ds_read_b128 v[104:107], v110 offset:53248
    v_mfma_f32_32x32x16_bf16 v[144:159], v[16:19], v[24:27], v[144:159]
    s_waitcnt vmcnt(8) lgkmcnt(6)
    v_mfma_f32_32x32x16_bf16 v[44:59], v[112:115], v[120:123], v[44:59]
    ds_read_b64_tr_b16 v[12:13], v160 offset:6144
    ds_read_b64_tr_b16 v[14:15], v160 offset:6656
    v_mfma_f32_32x32x16_bf16 v[60:75], v[112:115], v[124:127], v[60:75]
    ds_read_b64_tr_b16 v[16:17], v161 offset:6144
    ds_read_b64_tr_b16 v[18:19], v161 offset:6656
    v_mfma_f32_32x32x16_bf16 v[128:143], v[116:119], v[120:123], v[128:143]
    ds_read_b128 v[20:23], v111 offset:49152
    ds_read_b128 v[24:27], v111 offset:53248
    v_mfma_f32_32x32x16_bf16 v[144:159], v[116:119], v[124:127], v[144:159]
    s_waitcnt vmcnt(6) lgkmcnt(6)
    v_mfma_f32_32x32x16_bf16 v[44:59], v[92:95], v[100:103], v[44:59]
    ds_read_b64_tr_b16 v[112:113], v160 offset:8192
    ds_read_b64_tr_b16 v[114:115], v160 offset:8704
    v_mfma_f32_32x32x16_bf16 v[60:75], v[92:95], v[104:107], v[60:75]
    ds_read_b64_tr_b16 v[116:117], v161 offset:8192
    ds_read_b64_tr_b16 v[118:119], v161 offset:8704
    v_mfma_f32_32x32x16_bf16 v[128:143], v[96:99], v[100:103], v[128:143]
    ds_read_b128 v[120:123], v108 offset:57344
    ds_read_b128 v[124:127], v108 offset:61440
    v_mfma_f32_32x32x16_bf16 v[144:159], v[96:99], v[104:107], v[144:159]
    s_waitcnt vmcnt(4) lgkmcnt(6)
    v_mfma_f32_32x32x16_bf16 v[44:59], v[12:15], v[20:23], v[44:59]
    ds_read_b64_tr_b16 v[92:93], v160 offset:10240
    ds_read_b64_tr_b16 v[94:95], v160 offset:10752
    v_mfma_f32_32x32x16_bf16 v[60:75], v[12:15], v[24:27], v[60:75]
    ds_read_b64_tr_b16 v[96:97], v161 offset:10240
    ds_read_b64_tr_b16 v[98:99], v161 offset:10752
    v_mfma_f32_32x32x16_bf16 v[128:143], v[16:19], v[20:23], v[128:143]
    ds_read_b128 v[100:103], v109 offset:57344
    ds_read_b128 v[104:107], v109 offset:61440
    v_mfma_f32_32x32x16_bf16 v[144:159], v[16:19], v[24:27], v[144:159]
    s_waitcnt vmcnt(2) lgkmcnt(6)
    v_mfma_f32_32x32x16_bf16 v[44:59], v[112:115], v[120:123], v[44:59]
    ds_read_b64_tr_b16 v[12:13], v160 offset:12288
    ds_read_b64_tr_b16 v[14:15], v160 offset:12800
    v_mfma_f32_32x32x16_bf16 v[60:75], v[112:115], v[124:127], v[60:75]
    ds_read_b64_tr_b16 v[16:17], v161 offset:12288
    ds_read_b64_tr_b16 v[18:19], v161 offset:12800
    v_mfma_f32_32x32x16_bf16 v[128:143], v[116:119], v[120:123], v[128:143]
    ds_read_b128 v[20:23], v110 offset:57344
    ds_read_b128 v[24:27], v110 offset:61440
    v_mfma_f32_32x32x16_bf16 v[144:159], v[116:119], v[124:127], v[144:159]
    s_waitcnt vmcnt(0) lgkmcnt(6)
    v_mfma_f32_32x32x16_bf16 v[44:59], v[92:95], v[100:103], v[44:59]
    ds_read_b64_tr_b16 v[112:113], v160 offset:14336
    ds_read_b64_tr_b16 v[114:115], v160 offset:14848
    v_mfma_f32_32x32x16_bf16 v[60:75], v[92:95], v[104:107], v[60:75]
    ds_read_b64_tr_b16 v[116:117], v161 offset:14336
    ds_read_b64_tr_b16 v[118:119], v161 offset:14848
    v_mfma_f32_32x32x16_bf16 v[128:143], v[96:99], v[100:103], v[128:143]
    ds_read_b128 v[120:123], v111 offset:57344
    ds_read_b128 v[124:127], v111 offset:61440
    v_mfma_f32_32x32x16_bf16 v[144:159], v[96:99], v[104:107], v[144:159]
    s_waitcnt lgkmcnt(6)
    v_mfma_f32_32x32x16_bf16 v[44:59], v[12:15], v[20:23], v[44:59]
    v_mov_b32 v92, 0
    v_mov_b32 v93, 0
    v_mfma_f32_32x32x16_bf16 v[60:75], v[12:15], v[24:27], v[60:75]
    v_mov_b32 v94, 0
    v_mov_b32 v95, 0
    v_mfma_f32_32x32x16_bf16 v[128:143], v[16:19], v[20:23], v[128:143]
    v_mov_b32 v96, 0
    v_mov_b32 v97, 0
    v_mfma_f32_32x32x16_bf16 v[144:159], v[16:19], v[24:27], v[144:159]
    v_mov_b32 v98, 0
    v_mov_b32 v99, 0
    s_waitcnt lgkmcnt(0)
    v_mfma_f32_32x32x16_bf16 v[128:143], v[116:119], v[120:123], v[128:143]
    v_mov_b32 v100, 0
    v_mov_b32 v101, 0
    v_mfma_f32_32x32x16_bf16 v[144:159], v[116:119], v[124:127], v[144:159]
    v_mov_b32 v102, 0
    v_mov_b32 v103, 0
    v_mfma_f32_32x32x16_bf16 v[44:59], v[112:115], v[120:123], v[44:59]
    v_mov_b32 v104, 0
    v_mov_b32 v105, 0
    v_mfma_f32_32x32x16_bf16 v[60:75], v[112:115], v[124:127], v[60:75]
    v_mov_b32 v106, 0
    v_mov_b32 v107, 0
    s_cmp_eq_u32 s68, 0
    s_cbranch_scc1 L_A_GE0
    v_and_b32 v2, 0, v0
    v_lshlrev_b32 v2, 2, v2
    v_add_u32 v2, 163380, v2
    s_mov_b32 s84, 400000
tw_55:
    ds_read_b32 v3, v2
    s_waitcnt lgkmcnt(0)
    v_cmp_ne_u32 vcc, 1, v3
    s_cbranch_vccz twd_56
    s_sub_u32 s84, s84, 1
    s_cbranch_scc1 twd_56
    s_branch tw_55
twd_56:
    s_add_u32 m0, s79, 0
    s_add_u32 s76, s77, 0
    buffer_load_dwordx4 v6, s[60:63], s76 offen offset:0 sc1 lds
    buffer_load_dwordx4 v6, s[60:63], s76 offen offset:1024 sc1 lds
    s_add_u32 m0, s79, 2048
    s_add_u32 s76, s77, 2048
    buffer_load_dwordx4 v6, s[60:63], s76 offen offset:0 sc1 lds
    buffer_load_dwordx4 v6, s[60:63], s76 offen offset:1024 sc1 lds
    s_add_u32 m0, s79, 4096
    s_add_u32 s76, s77, 4096
    buffer_load_dwordx4 v6, s[60:63], s76 offen offset:0 sc1 lds
    buffer_load_dwordx4 v6, s[60:63], s76 offen offset:1024 sc1 lds
    s_add_u32 m0, s79, 6144
    s_add_u32 s76, s77, 6144
    buffer_load_dwordx4 v6, s[60:63], s76 offen offset:0 sc1 lds
    buffer_load_dwordx4 v6, s[60:63], s76 offen offset:1024 sc1 lds
    s_add_u32 m0, s79, 8192
    s_add_u32 s76, s77, 8192
    buffer_load_dwordx4 v6, s[60:63], s76 offen offset:0 sc1 lds
    buffer_load_dwordx4 v6, s[60:63], s76 offen offset:1024 sc1 lds
    s_add_u32 m0, s79, 10240
    s_add_u32 s76, s77, 10240
    buffer_load_dwordx4 v6, s[60:63], s76 offen offset:0 sc1 lds
    buffer_load_dwordx4 v6, s[60:63], s76 offen offset:1024 sc1 lds
    s_add_u32 m0, s79, 12288
    s_add_u32 s76, s77, 12288
    buffer_load_dwordx4 v6, s[60:63], s76 offen offset:0 sc1 lds
    buffer_load_dwordx4 v6, s[60:63], s76 offen offset:1024 sc1 lds
    s_add_u32 m0, s79, 14336
    s_add_u32 s76, s77, 14336
    buffer_load_dwordx4 v6, s[60:63], s76 offen offset:0 sc1 lds
    buffer_load_dwordx4 v6, s[60:63], s76 offen offset:1024 sc1 lds
    s_branch L_A_GE0
L_A_GK0:
    s_waitcnt vmcnt(10) lgkmcnt(6)
    v_mfma_f32_32x32x16_bf16 v[44:59], v[12:15], v[20:23], v[44:59]
    ds_read_b64_tr_b16 v[92:93], v160 offset:4096
    ds_read_b64_tr_b16 v[94:95], v160 offset:4608
    s_add_u32 m0, s79, 0
    s_add_u32 s76, s77, 0
    v_mfma_f32_32x32x16_bf16 v[60:75], v[12:15], v[24:27], v[60:75]
    ds_read_b64_tr_b16 v[96:97], v161 offset:4096
    ds_read_b64_tr_b16 v[98:99], v161 offset:4608
    buffer_load_dwordx4 v6, s[60:63], s76 offen offset:0 sc1 lds
    v_mfma_f32_32x32x16_bf16 v[128:143], v[16:19], v[20:23], v[128:143]
    ds_read_b128 v[100:103], v110 offset:49152
    ds_read_b128 v[104:107], v110 offset:53248
    v_mfma_f32_32x32x16_bf16 v[144:159], v[16:19], v[24:27], v[144:159]
    buffer_load_dwordx4 v6, s[60:63], s76 offen offset:1024 sc1 lds
    s_waitcnt vmcnt(10) lgkmcnt(6)
    v_mfma_f32_32x32x16_bf16 v[44:59], v[112:115], v[120:123], v[44:59]
    ds_read_b64_tr_b16 v[12:13], v160 offset:6144
    ds_read_b64_tr_b16 v[14:15], v160 offset:6656
    s_add_u32 m0, s79, 2048
    s_add_u32 s76, s77, 2048
    v_mfma_f32_32x32x16_bf16 v[60:75], v[112:115], v[124:127], v[60:75]
    ds_read_b64_tr_b16 v[16:17], v161 offset:6144
    ds_read_b64_tr_b16 v[18:19], v161 offset:6656
    buffer_load_dwordx4 v6, s[60:63], s76 offen offset:0 sc1 lds
    v_mfma_f32_32x32x16_bf16 v[128:143], v[116:119], v[120:123], v[128:143]
    ds_read_b128 v[20:23], v111 offset:49152
    ds_read_b128 v[24:27], v111 offset:53248
    v_mfma_f32_32x32x16_bf16 v[144:159], v[116:119], v[124:127], v[144:159]
    buffer_load_dwordx4 v6, s[60:63], s76 offen offset:1024 sc1 lds
    s_waitcnt vmcnt(10) lgkmcnt(6)
    v_mfma_f32_32x32x16_bf16 v[44:59], v[92:95], v[100:103], v[44:59]
    ds_read_b64_tr_b16 v[112:113], v160 offset:8192
    ds_read_b64_tr_b16 v[114:115], v160 offset:8704
    s_add_u32 m0, s79, 4096
    s_add_u32 s76, s77, 4096
    v_mfma_f32_32x32x16_bf16 v[60:75], v[92:95], v[104:107], v[60:75]
    ds_read_b64_tr_b16 v[116:117], v161 offset:8192
    ds_read_b64_tr_b16 v[118:119], v161 offset:8704
    buffer_load_dwordx4 v6, s[60:63], s76 offen offset:0 sc1 lds
    v_mfma_f32_32x32x16_bf16 v[128:143], v[96:99], v[100:103], v[128:143]
    ds_read_b128 v[120:123], v108 offset:57344
    ds_read_b128 v[124:127], v108 offset:61440
    v_mfma_f32_32x32x16_bf16 v[144:159], v[96:99], v[104:107], v[144:159]
    buffer_load_dwordx4 v6, s[60:63], s76 offen offset:1024 sc1 lds
    s_waitcnt vmcnt(10) lgkmcnt(6)
    v_mfma_f32_32x32x16_bf16 v[44:59], v[12:15], v[20:23], v[44:59]
    ds_read_b64_tr_b16 v[92:93], v160 offset:10240
    ds_read_b64_tr_b16 v[94:95], v160 offset:10752
    s_add_u32 m0, s79, 6144
    s_add_u32 s76, s77, 6144
    v_mfma_f32_32x32x16_bf16 v[60:75], v[12:15], v[24:27], v[60:75]
    ds_read_b64_tr_b16 v[96:97], v161 offset:10240
    ds_read_b64_tr_b16 v[98:99], v161 offset:10752
    buffer_load_dwordx4 v6, s[60:63], s76 offen offset:0 sc1 lds
    v_mfma_f32_32x32x16_bf16 v[128:143], v[16:19], v[20:23], v[128:143]
    ds_read_b128 v[100:103], v109 offset:57344
    ds_read_b128 v[104:107], v109 offset:61440
    v_mfma_f32_32x32x16_bf16 v[144:159], v[16:19], v[24:27], v[144:159]
    buffer_load_dwordx4 v6, s[60:63], s76 offen offset:1024 sc1 lds
    s_waitcnt vmcnt(10) lgkmcnt(6)
    v_mfma_f32_32x32x16_bf16 v[44:59], v[112:115], v[120:123], v[44:59]
    ds_read_b64_tr_b16 v[12:13], v160 offset:12288
    ds_read_b64_tr_b16 v[14:15], v160 offset:12800
    s_add_u32 m0, s79, 8192
    s_add_u32 s76, s77, 8192
    v_mfma_f32_32x32x16_bf16 v[60:75], v[112:115], v[124:127], v[60:75]
    ds_read_b64_tr_b16 v[16:17], v161 offset:12288
    ds_read_b64_tr_b16 v[18:19], v161 offset:12800
    buffer_load_dwordx4 v6, s[60:63], s76 offen offset:0 sc1 lds
    v_mfma_f32_32x32x16_bf16 v[128:143], v[116:119], v[120:123], v[128:143]
    ds_read_b128 v[20:23], v110 offset:57344
    ds_read_b128 v[24:27], v110 offset:61440
    v_mfma_f32_32x32x16_bf16 v[144:159], v[116:119], v[124:127], v[144:159]
    buffer_load_dwordx4 v6, s[60:63], s76 offen offset:1024 sc1 lds
    s_waitcnt vmcnt(10) lgkmcnt(6)
    v_mfma_f32_32x32x16_bf16 v[44:59], v[92:95], v[100:103], v[44:59]
    ds_read_b64_tr_b16 v[112:113], v160 offset:14336
    ds_read_b64_tr_b16 v[114:115], v160 offset:14848
    s_add_u32 m0, s79, 10240
    s_add_u32 s76, s77, 10240
    v_mfma_f32_32x32x16_bf16 v[60:75], v[92:95], v[104:107], v[60:75]
    ds_read_b64_tr_b16 v[116:117], v161 offset:14336
    ds_read_b64_tr_b16 v[118:119], v161 offset:14848
    buffer_load_dwordx4 v6, s[60:63], s76 offen offset:0 sc1 lds
    v_mfma_f32_32x32x16_bf16 v[128:143], v[96:99], v[100:103], v[128:143]
    ds_read_b128 v[120:123], v111 offset:57344
    ds_read_b128 v[124:127], v111 offset:61440
    v_mfma_f32_32x32x16_bf16 v[144:159], v[96:99], v[104:107], v[144:159]
    buffer_load_dwordx4 v6, s[60:63], s76 offen offset:1024 sc1 lds
    s_waitcnt lgkmcnt(6)
    v_mfma_f32_32x32x16_bf16 v[44:59], v[12:15], v[20:23], v[44:59]
    v_mov_b32 v92, 0
    v_mov_b32 v93, 0
    s_add_u32 m0, s79, 12288
    s_add_u32 s76, s77, 12288
    v_mfma_f32_32x32x16_bf16 v[60:75], v[12:15], v[24:27], v[60:75]
    v_mov_b32 v94, 0
    v_mov_b32 v95, 0
    buffer_load_dwordx4 v6, s[60:63], s76 offen offset:0 sc1 lds
    v_mfma_f32_32x32x16_bf16 v[128:143], v[16:19], v[20:23], v[128:143]
    v_mov_b32 v96, 0
    v_mov_b32 v97, 0
    v_mfma_f32_32x32x16_bf16 v[144:159], v[16:19], v[24:27], v[144:159]
    v_mov_b32 v98, 0
    v_mov_b32 v99, 0
    buffer_load_dwordx4 v6, s[60:63], s76 offen offset:1024 sc1 lds
    s_waitcnt lgkmcnt(0)
    v_mfma_f32_32x32x16_bf16 v[128:143], v[116:119], v[120:123], v[128:143]
    v_mov_b32 v100, 0
    v_mov_b32 v101, 0
    s_add_u32 m0, s79, 14336
    s_add_u32 s76, s77, 14336
    v_mfma_f32_32x32x16_bf16 v[144:159], v[116:119], v[124:127], v[144:159]
    v_mov_b32 v102, 0
    v_mov_b32 v103, 0
    buffer_load_dwordx4 v6, s[60:63], s76 offen offset:0 sc1 lds
    v_mfma_f32_32x32x16_bf16 v[44:59], v[112:115], v[120:123], v[44:59]
    v_mov_b32 v104, 0
    v_mov_b32 v105, 0
    v_mfma_f32_32x32x16_bf16 v[60:75], v[112:115], v[124:127], v[60:75]
    v_mov_b32 v106, 0
    v_mov_b32 v107, 0
    buffer_load_dwordx4 v6, s[60:63], s76 offen offset:1024 sc1 lds
L_A_GE0:
    s_setprio 3
    s_lshl_b32 s76, s70, 8
    s_lshl_b32 s77, s69, 1
    s_add_u32 s76, s76, s77
    s_lshl_b32 s76, s76, 11
    s_add_u32 s76, s76, 0x240000
    s_cmp_eq_u32 s68, 2
    s_cbranch_scc1 L_A_EK
    s_cmp_eq_u32 s68, 0
    s_cbranch_scc1 L_A_Q0
    v_and_b32 v2, 0, v0
    v_lshlrev_b32 v2, 2, v2
    v_add_u32 v2, 163392, v2
    s_mov_b32 s84, 400000
tw_57:
    ds_read_b32 v3, v2
    s_waitcnt lgkmcnt(0)
    v_cmp_ne_u32 vcc, 1, v3
    s_cbranch_vccz twd_58
    s_sub_u32 s84, s84, 1
    s_cbranch_scc1 twd_58
    s_branch tw_57
twd_58:
L_A_Q0:
    s_lshl_b32 s73, s68, 13
    s_add_u32 s73, s73, 0
    v_add_u32 v3, s73, v6
    s_mov_b32 s74, 0x3eb8aa3b
    s_mov_b32 s75, 0x3eb8aa3b
    s_lshl_b32 s73, s68, 2
    s_add_u32 s73, s73, 163428
    v_mov_b32 v4, s73
    v_mov_b32 v5, 1
    v_pk_mul_f32 v[128:129], v[128:129], s[74:75]
    v_pk_mul_f32 v[130:131], v[130:131], s[74:75]
    v_pk_mul_f32 v[132:133], v[132:133], s[74:75]
    v_pk_mul_f32 v[134:135], v[134:135], s[74:75]
    v_pk_mul_f32 v[136:137], v[136:137], s[74:75]
    v_pk_mul_f32 v[138:139], v[138:139], s[74:75]
    v_pk_mul_f32 v[140:141], v[140:141], s[74:75]
    v_pk_mul_f32 v[142:143], v[142:143], s[74:75]
    v_cvt_pk_bf16_f32 v128, v128, v129
    v_cvt_pk_bf16_f32 v129, v130, v131
    v_cvt_pk_bf16_f32 v130, v132, v133
    v_cvt_pk_bf16_f32 v131, v134, v135
    v_cvt_pk_bf16_f32 v132, v136, v137
    v_cvt_pk_bf16_f32 v133, v138, v139
    v_cvt_pk_bf16_f32 v134, v140, v141
    v_cvt_pk_bf16_f32 v135, v142, v143
    ds_write_b128 v3, v[128:131] offset:4096
    ds_write_b128 v3, v[132:135] offset:6144
    v_pk_mul_f32 v[144:145], v[144:145], s[74:75]
    v_pk_mul_f32 v[146:147], v[146:147], s[74:75]
    v_pk_mul_f32 v[148:149], v[148:149], s[74:75]
    v_pk_mul_f32 v[150:151], v[150:151], s[74:75]
    v_pk_mul_f32 v[152:153], v[152:153], s[74:75]
    v_pk_mul_f32 v[154:155], v[154:155], s[74:75]
    v_pk_mul_f32 v[156:157], v[156:157], s[74:75]
    v_pk_mul_f32 v[158:159], v[158:159], s[74:75]
    v_cvt_pk_bf16_f32 v144, v144, v145
    v_cvt_pk_bf16_f32 v145, v146, v147
    v_cvt_pk_bf16_f32 v146, v148, v149
    v_cvt_pk_bf16_f32 v147, v150, v151
    v_cvt_pk_bf16_f32 v148, v152, v153
    v_cvt_pk_bf16_f32 v149, v154, v155
    v_cvt_pk_bf16_f32 v150, v156, v157
    v_cvt_pk_bf16_f32 v151, v158, v159
    ds_write_b128 v3, v[144:147] offset:5120
    ds_write_b128 v3, v[148:151] offset:7168
    s_mov_b64 exec, 1
    ds_write_b32 v4, v5
    s_mov_b64 exec, -1
    v_pk_mul_f32 v[44:45], v[44:45], s[74:75]
    v_pk_mul_f32 v[46:47], v[46:47], s[74:75]
    v_pk_mul_f32 v[48:49], v[48:49], s[74:75]
    v_pk_mul_f32 v[50:51], v[50:51], s[74:75]
    v_pk_mul_f32 v[52:53], v[52:53], s[74:75]
    v_pk_mul_f32 v[54:55], v[54:55], s[74:75]
    v_pk_mul_f32 v[56:57], v[56:57], s[74:75]
    v_pk_mul_f32 v[58:59], v[58:59], s[74:75]
    v_cvt_pk_bf16_f32 v44, v44, v45
    v_cvt_pk_bf16_f32 v45, v46, v47
    v_cvt_pk_bf16_f32 v46, v48, v49
    v_cvt_pk_bf16_f32 v47, v50, v51
    v_cvt_pk_bf16_f32 v48, v52, v53
    v_cvt_pk_bf16_f32 v49, v54, v55
    v_cvt_pk_bf16_f32 v50, v56, v57
    v_cvt_pk_bf16_f32 v51, v58, v59
    ds_write_b128 v3, v[44:47] offset:0
    ds_write_b128 v3, v[48:51] offset:2048
    v_pk_mul_f32 v[60:61], v[60:61], s[74:75]
    v_pk_mul_f32 v[62:63], v[62:63], s[74:75]
    v_pk_mul_f32 v[64:65], v[64:65], s[74:75]
    v_pk_mul_f32 v[66:67], v[66:67], s[74:75]
    v_pk_mul_f32 v[68:69], v[68:69], s[74:75]
    v_pk_mul_f32 v[70:71], v[70:71], s[74:75]
    v_pk_mul_f32 v[72:73], v[72:73], s[74:75]
    v_pk_mul_f32 v[74:75], v[74:75], s[74:75]
    v_cvt_pk_bf16_f32 v60, v60, v61
    v_cvt_pk_bf16_f32 v61, v62, v63
    v_cvt_pk_bf16_f32 v62, v64, v65
    v_cvt_pk_bf16_f32 v63, v66, v67
    v_cvt_pk_bf16_f32 v64, v68, v69
    v_cvt_pk_bf16_f32 v65, v70, v71
    v_cvt_pk_bf16_f32 v66, v72, v73
    v_cvt_pk_bf16_f32 v67, v74, v75
    ds_write_b128 v3, v[60:63] offset:1024
    ds_write_b128 v3, v[64:67] offset:3072
    s_waitcnt vmcnt(0) lgkmcnt(0)
    s_lshl_b32 s72, s68, 2
    s_add_u32 s72, s72, 163392
    v_mov_b32 v2, s72
    v_mov_b32 v3, 1
    s_mov_b64 exec, 1
    ds_write_b32 v2, v3
    s_mov_b64 exec, -1
    s_branch L_A_B8
L_A_EK:
    s_waitcnt vmcnt(0)
    s_lshl_b32 s72, s68, 2
    s_add_u32 s72, s72, 163392
    v_mov_b32 v2, s72
    v_mov_b32 v3, 1
    s_mov_b64 exec, 1
    ds_write_b32 v2, v3
    s_mov_b64 exec, -1
    v_cvt_pk_bf16_f32 v44, v44, v45
    v_cvt_pk_bf16_f32 v45, v46, v47
    v_cvt_pk_bf16_f32 v46, v48, v49
    v_cvt_pk_bf16_f32 v47, v50, v51
    v_cvt_pk_bf16_f32 v48, v52, v53
    v_cvt_pk_bf16_f32 v49, v54, v55
    v_cvt_pk_bf16_f32 v50, v56, v57
    v_cvt_pk_bf16_f32 v51, v58, v59
    s_add_u32 s77, s76, 0
    buffer_store_dwordx4 v[44:47], v6, s[60:63], s77 offen offset:0 sc1
    s_add_u32 s77, s76, 131072
    buffer_store_dwordx4 v[48:51], v6, s[60:63], s77 offen offset:0 sc1
    v_cvt_pk_bf16_f32 v60, v60, v61
    v_cvt_pk_bf16_f32 v61, v62, v63
    v_cvt_pk_bf16_f32 v62, v64, v65
    v_cvt_pk_bf16_f32 v63, v66, v67
    v_cvt_pk_bf16_f32 v64, v68, v69
    v_cvt_pk_bf16_f32 v65, v70, v71
    v_cvt_pk_bf16_f32 v66, v72, v73
    v_cvt_pk_bf16_f32 v67, v74, v75
    s_add_u32 s77, s76, 0
    buffer_store_dwordx4 v[60:63], v6, s[60:63], s77 offen offset:2048 sc1
    s_add_u32 s77, s76, 131072
    buffer_store_dwordx4 v[64:67], v6, s[60:63], s77 offen offset:2048 sc1
    v_cvt_pk_bf16_f32 v128, v128, v129
    v_cvt_pk_bf16_f32 v129, v130, v131
    v_cvt_pk_bf16_f32 v130, v132, v133
    v_cvt_pk_bf16_f32 v131, v134, v135
    v_cvt_pk_bf16_f32 v132, v136, v137
    v_cvt_pk_bf16_f32 v133, v138, v139
    v_cvt_pk_bf16_f32 v134, v140, v141
    v_cvt_pk_bf16_f32 v135, v142, v143
    s_add_u32 s77, s76, 262144
    buffer_store_dwordx4 v[128:131], v6, s[60:63], s77 offen offset:0 sc1
    s_add_u32 s77, s76, 393216
    buffer_store_dwordx4 v[132:135], v6, s[60:63], s77 offen offset:0 sc1
    v_cvt_pk_bf16_f32 v144, v144, v145
    v_cvt_pk_bf16_f32 v145, v146, v147
    v_cvt_pk_bf16_f32 v146, v148, v149
    v_cvt_pk_bf16_f32 v147, v150, v151
    v_cvt_pk_bf16_f32 v148, v152, v153
    v_cvt_pk_bf16_f32 v149, v154, v155
    v_cvt_pk_bf16_f32 v150, v156, v157
    v_cvt_pk_bf16_f32 v151, v158, v159
    s_add_u32 s77, s76, 262144
    buffer_store_dwordx4 v[144:147], v6, s[60:63], s77 offen offset:2048 sc1
    s_add_u32 s77, s76, 393216
    buffer_store_dwordx4 v[148:151], v6, s[60:63], s77 offen offset:2048 sc1
    s_branch L_A_B8
L_A_GV:
    s_waitcnt vmcnt(10) lgkmcnt(6)
    v_mfma_f32_32x32x16_bf16 v[44:59], v[20:23], v[12:15], 0
    ds_read_b64_tr_b16 v[92:93], v160 offset:4096
    ds_read_b64_tr_b16 v[94:95], v160 offset:4608
    s_add_u32 m0, s79, 0
    s_add_u32 s75, s83, 2
    s_and_b32 s75, s75, 7
    s_lshl_b32 s75, s75, 2
    s_mul_i32 s75, s75, s82
    v_mfma_f32_32x32x16_bf16 v[60:75], v[24:27], v[12:15], 0
    ds_read_b64_tr_b16 v[96:97], v161 offset:4096
    ds_read_b64_tr_b16 v[98:99], v161 offset:4608
    buffer_load_dwordx4 v162, s[40:43], s75 offen lds
    v_mfma_f32_32x32x16_bf16 v[128:143], v[20:23], v[16:19], 0
    ds_read_b128 v[100:103], v110 offset:0
    ds_read_b128 v[104:107], v110 offset:4096
    v_mfma_f32_32x32x16_bf16 v[144:159], v[24:27], v[16:19], 0
    buffer_load_dwordx4 v163, s[40:43], s75 offen offset:1024 lds
    s_waitcnt vmcnt(10) lgkmcnt(6)
    v_mfma_f32_32x32x16_bf16 v[44:59], v[120:123], v[112:115], v[44:59]
    ds_read_b64_tr_b16 v[12:13], v160 offset:6144
    ds_read_b64_tr_b16 v[14:15], v160 offset:6656
    s_add_u32 m0, s79, 2048
    s_add_u32 s75, s75, s82
    v_mfma_f32_32x32x16_bf16 v[60:75], v[124:127], v[112:115], v[60:75]
    ds_read_b64_tr_b16 v[16:17], v161 offset:6144
    ds_read_b64_tr_b16 v[18:19], v161 offset:6656
    buffer_load_dwordx4 v162, s[40:43], s75 offen lds
    v_mfma_f32_32x32x16_bf16 v[128:143], v[120:123], v[116:119], v[128:143]
    ds_read_b128 v[20:23], v111 offset:0
    ds_read_b128 v[24:27], v111 offset:4096
    v_mfma_f32_32x32x16_bf16 v[144:159], v[124:127], v[116:119], v[144:159]
    buffer_load_dwordx4 v163, s[40:43], s75 offen offset:1024 lds
    s_waitcnt lgkmcnt(0)
    v_and_b32 v2, 3, v0
    v_lshlrev_b32 v2, 2, v2
    v_add_u32 v2, 163344, v2
    s_mov_b32 s84, 400000
tw_59:
    ds_read_b32 v3, v2
    s_waitcnt lgkmcnt(0)
    v_cmp_ne_u32 vcc, 1, v3
    s_cbranch_vccz twd_60
    s_sub_u32 s84, s84, 1
    s_cbranch_scc1 twd_60
    s_branch tw_59
twd_60:
    s_waitcnt vmcnt(10) lgkmcnt(6)
    v_mfma_f32_32x32x16_bf16 v[44:59], v[100:103], v[92:95], v[44:59]
    ds_read_b64_tr_b16 v[112:113], v160 offset:8192
    ds_read_b64_tr_b16 v[114:115], v160 offset:8704
    s_add_u32 m0, s79, 4096
    s_add_u32 s75, s75, s82
    v_mfma_f32_32x32x16_bf16 v[60:75], v[104:107], v[92:95], v[60:75]
    ds_read_b64_tr_b16 v[116:117], v161 offset:8192
    ds_read_b64_tr_b16 v[118:119], v161 offset:8704
    buffer_load_dwordx4 v162, s[40:43], s75 offen lds
    v_mfma_f32_32x32x16_bf16 v[128:143], v[100:103], v[96:99], v[128:143]
    ds_read_b128 v[120:123], v108 offset:8192
    ds_read_b128 v[124:127], v108 offset:12288
    v_mfma_f32_32x32x16_bf16 v[144:159], v[104:107], v[96:99], v[144:159]
    buffer_load_dwordx4 v163, s[40:43], s75 offen offset:1024 lds
    s_waitcnt vmcnt(10) lgkmcnt(6)
    v_mfma_f32_32x32x16_bf16 v[44:59], v[20:23], v[12:15], v[44:59]
    ds_read_b64_tr_b16 v[92:93], v160 offset:10240
    ds_read_b64_tr_b16 v[94:95], v160 offset:10752
    s_add_u32 m0, s79, 6144
    s_add_u32 s75, s75, s82
    v_mfma_f32_32x32x16_bf16 v[60:75], v[24:27], v[12:15], v[60:75]
    ds_read_b64_tr_b16 v[96:97], v161 offset:10240
    ds_read_b64_tr_b16 v[98:99], v161 offset:10752
    buffer_load_dwordx4 v162, s[40:43], s75 offen lds
    v_mfma_f32_32x32x16_bf16 v[128:143], v[20:23], v[16:19], v[128:143]
    ds_read_b128 v[100:103], v109 offset:8192
    ds_read_b128 v[104:107], v109 offset:12288
    v_mfma_f32_32x32x16_bf16 v[144:159], v[24:27], v[16:19], v[144:159]
    buffer_load_dwordx4 v163, s[40:43], s75 offen offset:1024 lds
    s_waitcnt vmcnt(10) lgkmcnt(6)
    v_mfma_f32_32x32x16_bf16 v[44:59], v[120:123], v[112:115], v[44:59]
    ds_read_b64_tr_b16 v[12:13], v160 offset:12288
    ds_read_b64_tr_b16 v[14:15], v160 offset:12800
    s_add_u32 m0, s79, 8192
    s_add_u32 s75, s83, 3
    s_and_b32 s75, s75, 7
    s_lshl_b32 s75, s75, 2
    s_mul_i32 s75, s75, s82
    v_mfma_f32_32x32x16_bf16 v[60:75], v[124:127], v[112:115], v[60:75]
    ds_read_b64_tr_b16 v[16:17], v161 offset:12288
    ds_read_b64_tr_b16 v[18:19], v161 offset:12800
    buffer_load_dwordx4 v162, s[40:43], s75 offen lds
    v_mfma_f32_32x32x16_bf16 v[128:143], v[120:123], v[116:119], v[128:143]
    ds_read_b128 v[20:23], v110 offset:8192
    ds_read_b128 v[24:27], v110 offset:12288
    v_mfma_f32_32x32x16_bf16 v[144:159], v[124:127], v[116:119], v[144:159]
    buffer_load_dwordx4 v163, s[40:43], s75 offen offset:1024 lds
    s_waitcnt vmcnt(10) lgkmcnt(6)
    v_mfma_f32_32x32x16_bf16 v[44:59], v[100:103], v[92:95], v[44:59]
    ds_read_b64_tr_b16 v[112:113], v160 offset:14336
    ds_read_b64_tr_b16 v[114:115], v160 offset:14848
    s_add_u32 m0, s79, 10240
    s_add_u32 s75, s75, s82
    v_mfma_f32_32x32x16_bf16 v[60:75], v[104:107], v[92:95], v[60:75]
    ds_read_b64_tr_b16 v[116:117], v161 offset:14336
    ds_read_b64_tr_b16 v[118:119], v161 offset:14848
    buffer_load_dwordx4 v162, s[40:43], s75 offen lds
    v_mfma_f32_32x32x16_bf16 v[128:143], v[100:103], v[96:99], v[128:143]
    ds_read_b128 v[120:123], v111 offset:8192
    ds_read_b128 v[124:127], v111 offset:12288
    v_mfma_f32_32x32x16_bf16 v[144:159], v[104:107], v[96:99], v[144:159]
    buffer_load_dwordx4 v163, s[40:43], s75 offen offset:1024 lds
    s_waitcnt vmcnt(10) lgkmcnt(6)
    v_mfma_f32_32x32x16_bf16 v[44:59], v[20:23], v[12:15], v[44:59]
    ds_read_b64_tr_b16 v[92:93], v160 offset:0
    ds_read_b64_tr_b16 v[94:95], v160 offset:512
    s_add_u32 m0, s79, 12288
    s_add_u32 s75, s75, s82
    v_mfma_f32_32x32x16_bf16 v[60:75], v[24:27], v[12:15], v[60:75]
    ds_read_b64_tr_b16 v[96:97], v161 offset:0
    ds_read_b64_tr_b16 v[98:99], v161 offset:512
    buffer_load_dwordx4 v162, s[40:43], s75 offen lds
    v_mfma_f32_32x32x16_bf16 v[128:143], v[20:23], v[16:19], v[128:143]
    ds_read_b128 v[100:103], v108 offset:16384
    ds_read_b128 v[104:107], v108 offset:20480
    v_mfma_f32_32x32x16_bf16 v[144:159], v[24:27], v[16:19], v[144:159]
    buffer_load_dwordx4 v163, s[40:43], s75 offen offset:1024 lds
    s_waitcnt vmcnt(10) lgkmcnt(6)
    v_mfma_f32_32x32x16_bf16 v[44:59], v[120:123], v[112:115], v[44:59]
    ds_read_b64_tr_b16 v[12:13], v160 offset:2048
    ds_read_b64_tr_b16 v[14:15], v160 offset:2560
    s_add_u32 m0, s79, 14336
    s_add_u32 s75, s75, s82
    v_mfma_f32_32x32x16_bf16 v[60:75], v[124:127], v[112:115], v[60:75]
    ds_read_b64_tr_b16 v[16:17], v161 offset:2048
    ds_read_b64_tr_b16 v[18:19], v161 offset:2560
    buffer_load_dwordx4 v162, s[40:43], s75 offen lds
    v_mfma_f32_32x32x16_bf16 v[128:143], v[120:123], v[116:119], v[128:143]
    ds_read_b128 v[20:23], v109 offset:16384
    ds_read_b128 v[24:27], v109 offset:20480
    v_mfma_f32_32x32x16_bf16 v[144:159], v[124:127], v[116:119], v[144:159]
    buffer_load_dwordx4 v163, s[40:43], s75 offen offset:1024 lds
    s_waitcnt vmcnt(10) lgkmcnt(6)
    v_mfma_f32_32x32x16_bf16 v[44:59], v[100:103], v[92:95], v[44:59]
    ds_read_b64_tr_b16 v[112:113], v160 offset:4096
    ds_read_b64_tr_b16 v[114:115], v160 offset:4608
    s_add_u32 m0, s79, 0
    s_add_u32 s75, s83, 4
    s_and_b32 s75, s75, 7
    s_lshl_b32 s75, s75, 2
    s_mul_i32 s75, s75, s82
    v_mfma_f32_32x32x16_bf16 v[60:75], v[104:107], v[92:95], v[60:75]
    ds_read_b64_tr_b16 v[116:117], v161 offset:4096
    ds_read_b64_tr_b16 v[118:119], v161 offset:4608
    buffer_load_dwordx4 v162, s[40:43], s75 offen lds
    v_mfma_f32_32x32x16_bf16 v[128:143], v[100:103], v[96:99], v[128:143]
    ds_read_b128 v[120:123], v110 offset:16384
    ds_read_b128 v[124:127], v110 offset:20480
    v_mfma_f32_32x32x16_bf16 v[144:159], v[104:107], v[96:99], v[144:159]
    buffer_load_dwordx4 v163, s[40:43], s75 offen offset:1024 lds
    s_waitcnt vmcnt(10) lgkmcnt(6)
    v_mfma_f32_32x32x16_bf16 v[44:59], v[20:23], v[12:15], v[44:59]
    ds_read_b64_tr_b16 v[92:93], v160 offset:6144
    ds_read_b64_tr_b16 v[94:95], v160 offset:6656
    s_add_u32 m0, s79, 2048
    s_add_u32 s75, s75, s82
    v_mfma_f32_32x32x16_bf16 v[60:75], v[24:27], v[12:15], v[60:75]
    ds_read_b64_tr_b16 v[96:97], v161 offset:6144
    ds_read_b64_tr_b16 v[98:99], v161 offset:6656
    buffer_load_dwordx4 v162, s[40:43], s75 offen lds
    v_mfma_f32_32x32x16_bf16 v[128:143], v[20:23], v[16:19], v[128:143]
    ds_read_b128 v[100:103], v111 offset:16384
    ds_read_b128 v[104:107], v111 offset:20480
    v_mfma_f32_32x32x16_bf16 v[144:159], v[24:27], v[16:19], v[144:159]
    buffer_load_dwordx4 v163, s[40:43], s75 offen offset:1024 lds
    s_waitcnt vmcnt(10) lgkmcnt(6)
    v_mfma_f32_32x32x16_bf16 v[44:59], v[120:123], v[112:115], v[44:59]
    ds_read_b64_tr_b16 v[12:13], v160 offset:8192
    ds_read_b64_tr_b16 v[14:15], v160 offset:8704
    s_add_u32 m0, s79, 4096
    s_add_u32 s75, s75, s82
    v_mfma_f32_32x32x16_bf16 v[60:75], v[124:127], v[112:115], v[60:75]
    ds_read_b64_tr_b16 v[16:17], v161 offset:8192
    ds_read_b64_tr_b16 v[18:19], v161 offset:8704
    buffer_load_dwordx4 v162, s[40:43], s75 offen lds
    v_mfma_f32_32x32x16_bf16 v[128:143], v[120:123], v[116:119], v[128:143]
    ds_read_b128 v[20:23], v108 offset:24576
    ds_read_b128 v[24:27], v108 offset:28672
    v_mfma_f32_32x32x16_bf16 v[144:159], v[124:127], v[116:119], v[144:159]
    buffer_load_dwordx4 v163, s[40:43], s75 offen offset:1024 lds
    s_waitcnt vmcnt(10) lgkmcnt(6)
    v_mfma_f32_32x32x16_bf16 v[44:59], v[100:103], v[92:95], v[44:59]
    ds_read_b64_tr_b16 v[112:113], v160 offset:10240
    ds_read_b64_tr_b16 v[114:115], v160 offset:10752
    s_add_u32 m0, s79, 6144
    s_add_u32 s75, s75, s82
    v_mfma_f32_32x32x16_bf16 v[60:75], v[104:107], v[92:95], v[60:75]
    ds_read_b64_tr_b16 v[116:117], v161 offset:10240
    ds_read_b64_tr_b16 v[118:119], v161 offset:10752
    buffer_load_dwordx4 v162, s[40:43], s75 offen lds
    v_mfma_f32_32x32x16_bf16 v[128:143], v[100:103], v[96:99], v[128:143]
    ds_read_b128 v[120:123], v109 offset:24576
    ds_read_b128 v[124:127], v109 offset:28672
    v_mfma_f32_32x32x16_bf16 v[144:159], v[104:107], v[96:99], v[144:159]
    buffer_load_dwordx4 v163, s[40:43], s75 offen offset:1024 lds
    s_waitcnt vmcnt(10) lgkmcnt(6)
    v_mfma_f32_32x32x16_bf16 v[44:59], v[20:23], v[12:15], v[44:59]
    ds_read_b64_tr_b16 v[92:93], v160 offset:12288
    ds_read_b64_tr_b16 v[94:95], v160 offset:12800
    s_add_u32 m0, s79, 8192
    s_add_u32 s75, s83, 5
    s_and_b32 s75, s75, 7
    s_lshl_b32 s75, s75, 2
    s_mul_i32 s75, s75, s82
    v_mfma_f32_32x32x16_bf16 v[60:75], v[24:27], v[12:15], v[60:75]
    ds_read_b64_tr_b16 v[96:97], v161 offset:12288
    ds_read_b64_tr_b16 v[98:99], v161 offset:12800
    buffer_load_dwordx4 v162, s[40:43], s75 offen lds
    v_mfma_f32_32x32x16_bf16 v[128:143], v[20:23], v[16:19], v[128:143]
    ds_read_b128 v[100:103], v110 offset:24576
    ds_read_b128 v[104:107], v110 offset:28672
    v_mfma_f32_32x32x16_bf16 v[144:159], v[24:27], v[16:19], v[144:159]
    buffer_load_dwordx4 v163, s[40:43], s75 offen offset:1024 lds
    s_waitcnt vmcnt(10) lgkmcnt(6)
    v_mfma_f32_32x32x16_bf16 v[44:59], v[120:123], v[112:115], v[44:59]
    ds_read_b64_tr_b16 v[12:13], v160 offset:14336
    ds_read_b64_tr_b16 v[14:15], v160 offset:14848
    s_add_u32 m0, s79, 10240
    s_add_u32 s75, s75, s82
    v_mfma_f32_32x32x16_bf16 v[60:75], v[124:127], v[112:115], v[60:75]
    ds_read_b64_tr_b16 v[16:17], v161 offset:14336
    ds_read_b64_tr_b16 v[18:19], v161 offset:14848
    buffer_load_dwordx4 v162, s[40:43], s75 offen lds
    v_mfma_f32_32x32x16_bf16 v[128:143], v[120:123], v[116:119], v[128:143]
    ds_read_b128 v[20:23], v111 offset:24576
    ds_read_b128 v[24:27], v111 offset:28672
    v_mfma_f32_32x32x16_bf16 v[144:159], v[124:127], v[116:119], v[144:159]
    buffer_load_dwordx4 v163, s[40:43], s75 offen offset:1024 lds
    s_waitcnt lgkmcnt(0)
    v_and_b32 v2, 3, v0
    v_lshlrev_b32 v2, 2, v2
    v_add_u32 v2, 163360, v2
    s_mov_b32 s84, 400000
tw_61:
    ds_read_b32 v3, v2
    s_waitcnt lgkmcnt(0)
    v_cmp_ne_u32 vcc, 1, v3
    s_cbranch_vccz twd_62
    s_sub_u32 s84, s84, 1
    s_cbranch_scc1 twd_62
    s_branch tw_61
twd_62:
    s_waitcnt vmcnt(10) lgkmcnt(6)
    v_mfma_f32_32x32x16_bf16 v[44:59], v[100:103], v[92:95], v[44:59]
    ds_read_b64_tr_b16 v[112:113], v160 offset:0
    ds_read_b64_tr_b16 v[114:115], v160 offset:512
    s_add_u32 m0, s79, 12288
    s_add_u32 s75, s75, s82
    v_mfma_f32_32x32x16_bf16 v[60:75], v[104:107], v[92:95], v[60:75]
    ds_read_b64_tr_b16 v[116:117], v161 offset:0
    ds_read_b64_tr_b16 v[118:119], v161 offset:512
    buffer_load_dwordx4 v162, s[40:43], s75 offen lds
    v_mfma_f32_32x32x16_bf16 v[128:143], v[100:103], v[96:99], v[128:143]
    ds_read_b128 v[120:123], v108 offset:32768
    ds_read_b128 v[124:127], v108 offset:36864
    v_mfma_f32_32x32x16_bf16 v[144:159], v[104:107], v[96:99], v[144:159]
    buffer_load_dwordx4 v163, s[40:43], s75 offen offset:1024 lds
    v_mov_b32 v2, 163376
    v_mov_b32 v3, 1
    s_mov_b64 exec, 1
    ds_write_b32 v2, v3
    s_mov_b64 exec, -1
    s_waitcnt lgkmcnt(0)
    s_waitcnt vmcnt(10) lgkmcnt(6)
    v_mfma_f32_32x32x16_bf16 v[44:59], v[20:23], v[12:15], v[44:59]
    ds_read_b64_tr_b16 v[92:93], v160 offset:2048
    ds_read_b64_tr_b16 v[94:95], v160 offset:2560
    s_add_u32 m0, s79, 14336
    s_add_u32 s75, s75, s82
    v_mfma_f32_32x32x16_bf16 v[60:75], v[24:27], v[12:15], v[60:75]
    ds_read_b64_tr_b16 v[96:97], v161 offset:2048
    ds_read_b64_tr_b16 v[98:99], v161 offset:2560
    buffer_load_dwordx4 v162, s[40:43], s75 offen lds
    v_mfma_f32_32x32x16_bf16 v[128:143], v[20:23], v[16:19], v[128:143]
    ds_read_b128 v[100:103], v109 offset:32768
    ds_read_b128 v[104:107], v109 offset:36864
    v_mfma_f32_32x32x16_bf16 v[144:159], v[24:27], v[16:19], v[144:159]
    buffer_load_dwordx4 v163, s[40:43], s75 offen offset:1024 lds
    s_waitcnt vmcnt(10) lgkmcnt(6)
    v_mfma_f32_32x32x16_bf16 v[44:59], v[120:123], v[112:115], v[44:59]
    ds_read_b64_tr_b16 v[12:13], v160 offset:4096
    ds_read_b64_tr_b16 v[14:15], v160 offset:4608
    s_add_u32 m0, s79, 0
    s_add_u32 s75, s83, 6
    s_and_b32 s75, s75, 7
    s_lshl_b32 s75, s75, 2
    s_mul_i32 s75, s75, s82
    v_mfma_f32_32x32x16_bf16 v[60:75], v[124:127], v[112:115], v[60:75]
    ds_read_b64_tr_b16 v[16:17], v161 offset:4096
    ds_read_b64_tr_b16 v[18:19], v161 offset:4608
    buffer_load_dwordx4 v162, s[40:43], s75 offen lds
    v_mfma_f32_32x32x16_bf16 v[128:143], v[120:123], v[116:119], v[128:143]
    ds_read_b128 v[20:23], v110 offset:32768
    ds_read_b128 v[24:27], v110 offset:36864
    v_mfma_f32_32x32x16_bf16 v[144:159], v[124:127], v[116:119], v[144:159]
    buffer_load_dwordx4 v163, s[40:43], s75 offen offset:1024 lds
    s_waitcnt vmcnt(10) lgkmcnt(6)
    v_mfma_f32_32x32x16_bf16 v[44:59], v[100:103], v[92:95], v[44:59]
    ds_read_b64_tr_b16 v[112:113], v160 offset:6144
    ds_read_b64_tr_b16 v[114:115], v160 offset:6656
    s_add_u32 m0, s79, 2048
    s_add_u32 s75, s75, s82
    v_mfma_f32_32x32x16_bf16 v[60:75], v[104:107], v[92:95], v[60:75]
    ds_read_b64_tr_b16 v[116:117], v161 offset:6144
    ds_read_b64_tr_b16 v[118:119], v161 offset:6656
    buffer_load_dwordx4 v162, s[40:43], s75 offen lds
    v_mfma_f32_32x32x16_bf16 v[128:143], v[100:103], v[96:99], v[128:143]
    ds_read_b128 v[120:123], v111 offset:32768
    ds_read_b128 v[124:127], v111 offset:36864
    v_mfma_f32_32x32x16_bf16 v[144:159], v[104:107], v[96:99], v[144:159]
    buffer_load_dwordx4 v163, s[40:43], s75 offen offset:1024 lds
    s_waitcnt vmcnt(10) lgkmcnt(6)
    v_mfma_f32_32x32x16_bf16 v[44:59], v[20:23], v[12:15], v[44:59]
    ds_read_b64_tr_b16 v[92:93], v160 offset:8192
    ds_read_b64_tr_b16 v[94:95], v160 offset:8704
    s_add_u32 m0, s79, 4096
    s_add_u32 s75, s75, s82
    v_mfma_f32_32x32x16_bf16 v[60:75], v[24:27], v[12:15], v[60:75]
    ds_read_b64_tr_b16 v[96:97], v161 offset:8192
    ds_read_b64_tr_b16 v[98:99], v161 offset:8704
    buffer_load_dwordx4 v162, s[40:43], s75 offen lds
    v_mfma_f32_32x32x16_bf16 v[128:143], v[20:23], v[16:19], v[128:143]
    ds_read_b128 v[100:103], v108 offset:40960
    ds_read_b128 v[104:107], v108 offset:45056
    v_mfma_f32_32x32x16_bf16 v[144:159], v[24:27], v[16:19], v[144:159]
    buffer_load_dwordx4 v163, s[40:43], s75 offen offset:1024 lds
    s_waitcnt vmcnt(10) lgkmcnt(6)
    v_mfma_f32_32x32x16_bf16 v[44:59], v[120:123], v[112:115], v[44:59]
    ds_read_b64_tr_b16 v[12:13], v160 offset:10240
    ds_read_b64_tr_b16 v[14:15], v160 offset:10752
    s_add_u32 m0, s79, 6144
    s_add_u32 s75, s75, s82
    v_mfma_f32_32x32x16_bf16 v[60:75], v[124:127], v[112:115], v[60:75]
    ds_read_b64_tr_b16 v[16:17], v161 offset:10240
    ds_read_b64_tr_b16 v[18:19], v161 offset:10752
    buffer_load_dwordx4 v162, s[40:43], s75 offen lds
    v_mfma_f32_32x32x16_bf16 v[128:143], v[120:123], v[116:119], v[128:143]
    ds_read_b128 v[20:23], v109 offset:40960
    ds_read_b128 v[24:27], v109 offset:45056
    v_mfma_f32_32x32x16_bf16 v[144:159], v[124:127], v[116:119], v[144:159]
    buffer_load_dwordx4 v163, s[40:43], s75 offen offset:1024 lds
    s_waitcnt vmcnt(10) lgkmcnt(6)
    v_mfma_f32_32x32x16_bf16 v[44:59], v[100:103], v[92:95], v[44:59]
    ds_read_b64_tr_b16 v[112:113], v160 offset:12288
    ds_read_b64_tr_b16 v[114:115], v160 offset:12800
    s_add_u32 m0, s79, 8192
    s_add_u32 s75, s83, 7
    s_and_b32 s75, s75, 7
    s_lshl_b32 s75, s75, 2
    s_mul_i32 s75, s75, s82
    v_mfma_f32_32x32x16_bf16 v[60:75], v[104:107], v[92:95], v[60:75]
    ds_read_b64_tr_b16 v[116:117], v161 offset:12288
    ds_read_b64_tr_b16 v[118:119], v161 offset:12800
    buffer_load_dwordx4 v162, s[40:43], s75 offen lds
    v_mfma_f32_32x32x16_bf16 v[128:143], v[100:103], v[96:99], v[128:143]
    ds_read_b128 v[120:123], v110 offset:40960
    ds_read_b128 v[124:127], v110 offset:45056
    v_mfma_f32_32x32x16_bf16 v[144:159], v[104:107], v[96:99], v[144:159]
    buffer_load_dwordx4 v163, s[40:43], s75 offen offset:1024 lds
    s_waitcnt vmcnt(10) lgkmcnt(6)
    v_mfma_f32_32x32x16_bf16 v[44:59], v[20:23], v[12:15], v[44:59]
    ds_read_b64_tr_b16 v[92:93], v160 offset:14336
    ds_read_b64_tr_b16 v[94:95], v160 offset:14848
    s_add_u32 m0, s79, 10240
    s_add_u32 s75, s75, s82
    v_mfma_f32_32x32x16_bf16 v[60:75], v[24:27], v[12:15], v[60:75]
    ds_read_b64_tr_b16 v[96:97], v161 offset:14336
    ds_read_b64_tr_b16 v[98:99], v161 offset:14848
    buffer_load_dwordx4 v162, s[40:43], s75 offen lds
    v_mfma_f32_32x32x16_bf16 v[128:143], v[20:23], v[16:19], v[128:143]
    ds_read_b128 v[100:103], v111 offset:40960
    ds_read_b128 v[104:107], v111 offset:45056
    v_mfma_f32_32x32x16_bf16 v[144:159], v[24:27], v[16:19], v[144:159]
    buffer_load_dwordx4 v163, s[40:43], s75 offen offset:1024 lds
    s_waitcnt vmcnt(10) lgkmcnt(6)
    v_mfma_f32_32x32x16_bf16 v[44:59], v[120:123], v[112:115], v[44:59]
    ds_read_b64_tr_b16 v[12:13], v160 offset:0
    ds_read_b64_tr_b16 v[14:15], v160 offset:512
    s_add_u32 m0, s79, 12288
    s_add_u32 s75, s75, s82
    v_mfma_f32_32x32x16_bf16 v[60:75], v[124:127], v[112:115], v[60:75]
    ds_read_b64_tr_b16 v[16:17], v161 offset:0
    ds_read_b64_tr_b16 v[18:19], v161 offset:512
    buffer_load_dwordx4 v162, s[40:43], s75 offen lds
    v_mfma_f32_32x32x16_bf16 v[128:143], v[120:123], v[116:119], v[128:143]
    ds_read_b128 v[20:23], v108 offset:49152
    ds_read_b128 v[24:27], v108 offset:53248
    v_mfma_f32_32x32x16_bf16 v[144:159], v[124:127], v[116:119], v[144:159]
    buffer_load_dwordx4 v163, s[40:43], s75 offen offset:1024 lds
    s_waitcnt vmcnt(10) lgkmcnt(6)
    v_mfma_f32_32x32x16_bf16 v[44:59], v[100:103], v[92:95], v[44:59]
    ds_read_b64_tr_b16 v[112:113], v160 offset:2048
    ds_read_b64_tr_b16 v[114:115], v160 offset:2560
    s_add_u32 m0, s79, 14336
    s_add_u32 s75, s75, s82
    v_mfma_f32_32x32x16_bf16 v[60:75], v[104:107], v[92:95], v[60:75]
    ds_read_b64_tr_b16 v[116:117], v161 offset:2048
    ds_read_b64_tr_b16 v[118:119], v161 offset:2560
    buffer_load_dwordx4 v162, s[40:43], s75 offen lds
    v_mfma_f32_32x32x16_bf16 v[128:143], v[100:103], v[96:99], v[128:143]
    ds_read_b128 v[120:123], v109 offset:49152
    ds_read_b128 v[124:127], v109 offset:53248
    v_mfma_f32_32x32x16_bf16 v[144:159], v[104:107], v[96:99], v[144:159]
    buffer_load_dwordx4 v163, s[40:43], s75 offen offset:1024 lds
    v_and_b32 v2, 0, v0
    v_lshlrev_b32 v2, 2, v2
    v_add_u32 v2, 163380, v2
    ds_read_b32 v3, v2
    s_waitcnt lgkmcnt(0)
    v_cmp_ne_u32 vcc, 1, v3
    s_cbranch_vccz L_A_GK1
    s_waitcnt vmcnt(10) lgkmcnt(6)
    v_mfma_f32_32x32x16_bf16 v[44:59], v[20:23], v[12:15], v[44:59]
    ds_read_b64_tr_b16 v[92:93], v160 offset:4096
    ds_read_b64_tr_b16 v[94:95], v160 offset:4608
    v_mfma_f32_32x32x16_bf16 v[60:75], v[24:27], v[12:15], v[60:75]
    ds_read_b64_tr_b16 v[96:97], v161 offset:4096
    ds_read_b64_tr_b16 v[98:99], v161 offset:4608
    v_mfma_f32_32x32x16_bf16 v[128:143], v[20:23], v[16:19], v[128:143]
    ds_read_b128 v[100:103], v110 offset:49152
    ds_read_b128 v[104:107], v110 offset:53248
    v_mfma_f32_32x32x16_bf16 v[144:159], v[24:27], v[16:19], v[144:159]
    s_waitcnt vmcnt(8) lgkmcnt(6)
    v_mfma_f32_32x32x16_bf16 v[44:59], v[120:123], v[112:115], v[44:59]
    ds_read_b64_tr_b16 v[12:13], v160 offset:6144
    ds_read_b64_tr_b16 v[14:15], v160 offset:6656
    v_mfma_f32_32x32x16_bf16 v[60:75], v[124:127], v[112:115], v[60:75]
    ds_read_b64_tr_b16 v[16:17], v161 offset:6144
    ds_read_b64_tr_b16 v[18:19], v161 offset:6656
    v_mfma_f32_32x32x16_bf16 v[128:143], v[120:123], v[116:119], v[128:143]
    ds_read_b128 v[20:23], v111 offset:49152
    ds_read_b128 v[24:27], v111 offset:53248
    v_mfma_f32_32x32x16_bf16 v[144:159], v[124:127], v[116:119], v[144:159]
    s_waitcnt vmcnt(6) lgkmcnt(6)
    v_mfma_f32_32x32x16_bf16 v[44:59], v[100:103], v[92:95], v[44:59]
    ds_read_b64_tr_b16 v[112:113], v160 offset:8192
    ds_read_b64_tr_b16 v[114:115], v160 offset:8704
    v_mfma_f32_32x32x16_bf16 v[60:75], v[104:107], v[92:95], v[60:75]
    ds_read_b64_tr_b16 v[116:117], v161 offset:8192
    ds_read_b64_tr_b16 v[118:119], v161 offset:8704
    v_mfma_f32_32x32x16_bf16 v[128:143], v[100:103], v[96:99], v[128:143]
    ds_read_b128 v[120:123], v108 offset:57344
    ds_read_b128 v[124:127], v108 offset:61440
    v_mfma_f32_32x32x16_bf16 v[144:159], v[104:107], v[96:99], v[144:159]
    s_waitcnt vmcnt(4) lgkmcnt(6)
    v_mfma_f32_32x32x16_bf16 v[44:59], v[20:23], v[12:15], v[44:59]
    ds_read_b64_tr_b16 v[92:93], v160 offset:10240
    ds_read_b64_tr_b16 v[94:95], v160 offset:10752
    v_mfma_f32_32x32x16_bf16 v[60:75], v[24:27], v[12:15], v[60:75]
    ds_read_b64_tr_b16 v[96:97], v161 offset:10240
    ds_read_b64_tr_b16 v[98:99], v161 offset:10752
    v_mfma_f32_32x32x16_bf16 v[128:143], v[20:23], v[16:19], v[128:143]
    ds_read_b128 v[100:103], v109 offset:57344
    ds_read_b128 v[104:107], v109 offset:61440
    v_mfma_f32_32x32x16_bf16 v[144:159], v[24:27], v[16:19], v[144:159]
    s_waitcnt vmcnt(2) lgkmcnt(6)
    v_mfma_f32_32x32x16_bf16 v[44:59], v[120:123], v[112:115], v[44:59]
    ds_read_b64_tr_b16 v[12:13], v160 offset:12288
    ds_read_b64_tr_b16 v[14:15], v160 offset:12800
    v_mfma_f32_32x32x16_bf16 v[60:75], v[124:127], v[112:115], v[60:75]
    ds_read_b64_tr_b16 v[16:17], v161 offset:12288
    ds_read_b64_tr_b16 v[18:19], v161 offset:12800
    v_mfma_f32_32x32x16_bf16 v[128:143], v[120:123], v[116:119], v[128:143]
    ds_read_b128 v[20:23], v110 offset:57344
    ds_read_b128 v[24:27], v110 offset:61440
    v_mfma_f32_32x32x16_bf16 v[144:159], v[124:127], v[116:119], v[144:159]
    s_waitcnt vmcnt(0) lgkmcnt(6)
    v_mfma_f32_32x32x16_bf16 v[44:59], v[100:103], v[92:95], v[44:59]
    ds_read_b64_tr_b16 v[112:113], v160 offset:14336
    ds_read_b64_tr_b16 v[114:115], v160 offset:14848
    v_mfma_f32_32x32x16_bf16 v[60:75], v[104:107], v[92:95], v[60:75]
    ds_read_b64_tr_b16 v[116:117], v161 offset:14336
    ds_read_b64_tr_b16 v[118:119], v161 offset:14848
    v_mfma_f32_32x32x16_bf16 v[128:143], v[100:103], v[96:99], v[128:143]
    ds_read_b128 v[120:123], v111 offset:57344
    ds_read_b128 v[124:127], v111 offset:61440
    v_mfma_f32_32x32x16_bf16 v[144:159], v[104:107], v[96:99], v[144:159]
    s_waitcnt lgkmcnt(6)
    v_mfma_f32_32x32x16_bf16 v[44:59], v[20:23], v[12:15], v[44:59]
    v_mov_b32 v92, 0
    v_mov_b32 v93, 0
    v_mfma_f32_32x32x16_bf16 v[60:75], v[24:27], v[12:15], v[60:75]
    v_mov_b32 v94, 0
    v_mov_b32 v95, 0
    v_mfma_f32_32x32x16_bf16 v[128:143], v[20:23], v[16:19], v[128:143]
    v_mov_b32 v96, 0
    v_mov_b32 v97, 0
    v_mfma_f32_32x32x16_bf16 v[144:159], v[24:27], v[16:19], v[144:159]
    v_mov_b32 v98, 0
    v_mov_b32 v99, 0
    s_waitcnt lgkmcnt(0)
    v_mfma_f32_32x32x16_bf16 v[128:143], v[120:123], v[116:119], v[128:143]
    v_mov_b32 v100, 0
    v_mov_b32 v101, 0
    v_mfma_f32_32x32x16_bf16 v[144:159], v[124:127], v[116:119], v[144:159]
    v_mov_b32 v102, 0
    v_mov_b32 v103, 0
    v_mfma_f32_32x32x16_bf16 v[44:59], v[120:123], v[112:115], v[44:59]
    v_mov_b32 v104, 0
    v_mov_b32 v105, 0
    v_mfma_f32_32x32x16_bf16 v[60:75], v[124:127], v[112:115], v[60:75]
    v_mov_b32 v106, 0
    v_mov_b32 v107, 0
    v_and_b32 v2, 0, v0
    v_lshlrev_b32 v2, 2, v2
    v_add_u32 v2, 163380, v2
    s_mov_b32 s84, 400000
tw_65:
    ds_read_b32 v3, v2
    s_waitcnt lgkmcnt(0)
    v_cmp_ne_u32 vcc, 1, v3
    s_cbranch_vccz twd_66
    s_sub_u32 s84, s84, 1
    s_cbranch_scc1 twd_66
    s_branch tw_65
twd_66:
    s_add_u32 m0, s79, 0
    s_add_u32 s76, s77, 0
    buffer_load_dwordx4 v6, s[60:63], s76 offen offset:0 sc1 lds
    buffer_load_dwordx4 v6, s[60:63], s76 offen offset:1024 sc1 lds
    s_add_u32 m0, s79, 2048
    s_add_u32 s76, s77, 2048
    buffer_load_dwordx4 v6, s[60:63], s76 offen offset:0 sc1 lds
    buffer_load_dwordx4 v6, s[60:63], s76 offen offset:1024 sc1 lds
    s_add_u32 m0, s79, 4096
    s_add_u32 s76, s77, 4096
    buffer_load_dwordx4 v6, s[60:63], s76 offen offset:0 sc1 lds
    buffer_load_dwordx4 v6, s[60:63], s76 offen offset:1024 sc1 lds
    s_add_u32 m0, s79, 6144
    s_add_u32 s76, s77, 6144
    buffer_load_dwordx4 v6, s[60:63], s76 offen offset:0 sc1 lds
    buffer_load_dwordx4 v6, s[60:63], s76 offen offset:1024 sc1 lds
    s_add_u32 m0, s79, 8192
    s_add_u32 s76, s77, 8192
    buffer_load_dwordx4 v6, s[60:63], s76 offen offset:0 sc1 lds
    buffer_load_dwordx4 v6, s[60:63], s76 offen offset:1024 sc1 lds
    s_add_u32 m0, s79, 10240
    s_add_u32 s76, s77, 10240
    buffer_load_dwordx4 v6, s[60:63], s76 offen offset:0 sc1 lds
    buffer_load_dwordx4 v6, s[60:63], s76 offen offset:1024 sc1 lds
    s_add_u32 m0, s79, 12288
    s_add_u32 s76, s77, 12288
    buffer_load_dwordx4 v6, s[60:63], s76 offen offset:0 sc1 lds
    buffer_load_dwordx4 v6, s[60:63], s76 offen offset:1024 sc1 lds
    s_add_u32 m0, s79, 14336
    s_add_u32 s76, s77, 14336
    buffer_load_dwordx4 v6, s[60:63], s76 offen offset:0 sc1 lds
    buffer_load_dwordx4 v6, s[60:63], s76 offen offset:1024 sc1 lds
    s_branch L_A_GE1
L_A_GK1:
    s_waitcnt vmcnt(10) lgkmcnt(6)
    v_mfma_f32_32x32x16_bf16 v[44:59], v[20:23], v[12:15], v[44:59]
    ds_read_b64_tr_b16 v[92:93], v160 offset:4096
    ds_read_b64_tr_b16 v[94:95], v160 offset:4608
    s_add_u32 m0, s79, 0
    s_add_u32 s76, s77, 0
    v_mfma_f32_32x32x16_bf16 v[60:75], v[24:27], v[12:15], v[60:75]
    ds_read_b64_tr_b16 v[96:97], v161 offset:4096
    ds_read_b64_tr_b16 v[98:99], v161 offset:4608
    buffer_load_dwordx4 v6, s[60:63], s76 offen offset:0 sc1 lds
    v_mfma_f32_32x32x16_bf16 v[128:143], v[20:23], v[16:19], v[128:143]
    ds_read_b128 v[100:103], v110 offset:49152
    ds_read_b128 v[104:107], v110 offset:53248
    v_mfma_f32_32x32x16_bf16 v[144:159], v[24:27], v[16:19], v[144:159]
    buffer_load_dwordx4 v6, s[60:63], s76 offen offset:1024 sc1 lds
    s_waitcnt vmcnt(10) lgkmcnt(6)
    v_mfma_f32_32x32x16_bf16 v[44:59], v[120:123], v[112:115], v[44:59]
    ds_read_b64_tr_b16 v[12:13], v160 offset:6144
    ds_read_b64_tr_b16 v[14:15], v160 offset:6656
    s_add_u32 m0, s79, 2048
    s_add_u32 s76, s77, 2048
    v_mfma_f32_32x32x16_bf16 v[60:75], v[124:127], v[112:115], v[60:75]
    ds_read_b64_tr_b16 v[16:17], v161 offset:6144
    ds_read_b64_tr_b16 v[18:19], v161 offset:6656
    buffer_load_dwordx4 v6, s[60:63], s76 offen offset:0 sc1 lds
    v_mfma_f32_32x32x16_bf16 v[128:143], v[120:123], v[116:119], v[128:143]
    ds_read_b128 v[20:23], v111 offset:49152
    ds_read_b128 v[24:27], v111 offset:53248
    v_mfma_f32_32x32x16_bf16 v[144:159], v[124:127], v[116:119], v[144:159]
    buffer_load_dwordx4 v6, s[60:63], s76 offen offset:1024 sc1 lds
    s_waitcnt vmcnt(10) lgkmcnt(6)
    v_mfma_f32_32x32x16_bf16 v[44:59], v[100:103], v[92:95], v[44:59]
    ds_read_b64_tr_b16 v[112:113], v160 offset:8192
    ds_read_b64_tr_b16 v[114:115], v160 offset:8704
    s_add_u32 m0, s79, 4096
    s_add_u32 s76, s77, 4096
    v_mfma_f32_32x32x16_bf16 v[60:75], v[104:107], v[92:95], v[60:75]
    ds_read_b64_tr_b16 v[116:117], v161 offset:8192
    ds_read_b64_tr_b16 v[118:119], v161 offset:8704
    buffer_load_dwordx4 v6, s[60:63], s76 offen offset:0 sc1 lds
    v_mfma_f32_32x32x16_bf16 v[128:143], v[100:103], v[96:99], v[128:143]
    ds_read_b128 v[120:123], v108 offset:57344
    ds_read_b128 v[124:127], v108 offset:61440
    v_mfma_f32_32x32x16_bf16 v[144:159], v[104:107], v[96:99], v[144:159]
    buffer_load_dwordx4 v6, s[60:63], s76 offen offset:1024 sc1 lds
    s_waitcnt vmcnt(10) lgkmcnt(6)
    v_mfma_f32_32x32x16_bf16 v[44:59], v[20:23], v[12:15], v[44:59]
    ds_read_b64_tr_b16 v[92:93], v160 offset:10240
    ds_read_b64_tr_b16 v[94:95], v160 offset:10752
    s_add_u32 m0, s79, 6144
    s_add_u32 s76, s77, 6144
    v_mfma_f32_32x32x16_bf16 v[60:75], v[24:27], v[12:15], v[60:75]
    ds_read_b64_tr_b16 v[96:97], v161 offset:10240
    ds_read_b64_tr_b16 v[98:99], v161 offset:10752
    buffer_load_dwordx4 v6, s[60:63], s76 offen offset:0 sc1 lds
    v_mfma_f32_32x32x16_bf16 v[128:143], v[20:23], v[16:19], v[128:143]
    ds_read_b128 v[100:103], v109 offset:57344
    ds_read_b128 v[104:107], v109 offset:61440
    v_mfma_f32_32x32x16_bf16 v[144:159], v[24:27], v[16:19], v[144:159]
    buffer_load_dwordx4 v6, s[60:63], s76 offen offset:1024 sc1 lds
    s_waitcnt vmcnt(10) lgkmcnt(6)
    v_mfma_f32_32x32x16_bf16 v[44:59], v[120:123], v[112:115], v[44:59]
    ds_read_b64_tr_b16 v[12:13], v160 offset:12288
    ds_read_b64_tr_b16 v[14:15], v160 offset:12800
    s_add_u32 m0, s79, 8192
    s_add_u32 s76, s77, 8192
    v_mfma_f32_32x32x16_bf16 v[60:75], v[124:127], v[112:115], v[60:75]
    ds_read_b64_tr_b16 v[16:17], v161 offset:12288
    ds_read_b64_tr_b16 v[18:19], v161 offset:12800
    buffer_load_dwordx4 v6, s[60:63], s76 offen offset:0 sc1 lds
    v_mfma_f32_32x32x16_bf16 v[128:143], v[120:123], v[116:119], v[128:143]
    ds_read_b128 v[20:23], v110 offset:57344
    ds_read_b128 v[24:27], v110 offset:61440
    v_mfma_f32_32x32x16_bf16 v[144:159], v[124:127], v[116:119], v[144:159]
    buffer_load_dwordx4 v6, s[60:63], s76 offen offset:1024 sc1 lds
    s_waitcnt vmcnt(10) lgkmcnt(6)
    v_mfma_f32_32x32x16_bf16 v[44:59], v[100:103], v[92:95], v[44:59]
    ds_read_b64_tr_b16 v[112:113], v160 offset:14336
    ds_read_b64_tr_b16 v[114:115], v160 offset:14848
    s_add_u32 m0, s79, 10240
    s_add_u32 s76, s77, 10240
    v_mfma_f32_32x32x16_bf16 v[60:75], v[104:107], v[92:95], v[60:75]
    ds_read_b64_tr_b16 v[116:117], v161 offset:14336
    ds_read_b64_tr_b16 v[118:119], v161 offset:14848
    buffer_load_dwordx4 v6, s[60:63], s76 offen offset:0 sc1 lds
    v_mfma_f32_32x32x16_bf16 v[128:143], v[100:103], v[96:99], v[128:143]
    ds_read_b128 v[120:123], v111 offset:57344
    ds_read_b128 v[124:127], v111 offset:61440
    v_mfma_f32_32x32x16_bf16 v[144:159], v[104:107], v[96:99], v[144:159]
    buffer_load_dwordx4 v6, s[60:63], s76 offen offset:1024 sc1 lds
    s_waitcnt lgkmcnt(6)
    v_mfma_f32_32x32x16_bf16 v[44:59], v[20:23], v[12:15], v[44:59]
    v_mov_b32 v92, 0
    v_mov_b32 v93, 0
    s_add_u32 m0, s79, 12288
    s_add_u32 s76, s77, 12288
    v_mfma_f32_32x32x16_bf16 v[60:75], v[24:27], v[12:15], v[60:75]
    v_mov_b32 v94, 0
    v_mov_b32 v95, 0
    buffer_load_dwordx4 v6, s[60:63], s76 offen offset:0 sc1 lds
    v_mfma_f32_32x32x16_bf16 v[128:143], v[20:23], v[16:19], v[128:143]
    v_mov_b32 v96, 0
    v_mov_b32 v97, 0
    v_mfma_f32_32x32x16_bf16 v[144:159], v[24:27], v[16:19], v[144:159]
    v_mov_b32 v98, 0
    v_mov_b32 v99, 0
    buffer_load_dwordx4 v6, s[60:63], s76 offen offset:1024 sc1 lds
    s_waitcnt lgkmcnt(0)
    v_mfma_f32_32x32x16_bf16 v[128:143], v[120:123], v[116:119], v[128:143]
    v_mov_b32 v100, 0
    v_mov_b32 v101, 0
    s_add_u32 m0, s79, 14336
    s_add_u32 s76, s77, 14336
    v_mfma_f32_32x32x16_bf16 v[144:159], v[124:127], v[116:119], v[144:159]
    v_mov_b32 v102, 0
    v_mov_b32 v103, 0
    buffer_load_dwordx4 v6, s[60:63], s76 offen offset:0 sc1 lds
    v_mfma_f32_32x32x16_bf16 v[44:59], v[120:123], v[112:115], v[44:59]
    v_mov_b32 v104, 0
    v_mov_b32 v105, 0
    v_mfma_f32_32x32x16_bf16 v[60:75], v[124:127], v[112:115], v[60:75]
    v_mov_b32 v106, 0
    v_mov_b32 v107, 0
    buffer_load_dwordx4 v6, s[60:63], s76 offen offset:1024 sc1 lds
L_A_GE1:
    s_setprio 3
    s_lshl_b32 s76, s70, 8
    s_lshl_b32 s77, s69, 1
    s_add_u32 s76, s76, s77
    s_lshl_b32 s76, s76, 11
    s_add_u32 s76, s76, 0x240000
    s_waitcnt vmcnt(0)
    s_lshl_b32 s72, s68, 2
    s_add_u32 s72, s72, 163392
    v_mov_b32 v2, s72
    v_mov_b32 v3, 1
    s_mov_b64 exec, 1
    ds_write_b32 v2, v3
    s_mov_b64 exec, -1
    v_bfe_u32 v3, v0, 4, 1
    v_lshl_add_u32 v3, v3, 17, v7
    v_cvt_pk_bf16_f32 v44, v44, v45
    v_cvt_pk_bf16_f32 v45, v46, v47
    v_cvt_pk_bf16_f32 v46, v48, v49
    v_cvt_pk_bf16_f32 v47, v50, v51
    v_cvt_pk_bf16_f32 v48, v52, v53
    v_cvt_pk_bf16_f32 v49, v54, v55
    v_cvt_pk_bf16_f32 v50, v56, v57
    v_cvt_pk_bf16_f32 v51, v58, v59
    s_nop 1
    v_permlane32_swap_b32 v44, v46
    v_permlane32_swap_b32 v45, v47
    v_permlane32_swap_b32 v48, v50
    v_permlane32_swap_b32 v49, v51
    s_add_u32 s77, s76, 0
    buffer_store_dwordx4 v[44:47], v3, s[60:63], s77 offen offset:1024 sc1
    buffer_store_dwordx4 v[48:51], v3, s[60:63], s77 offen offset:1536 sc1
    v_cvt_pk_bf16_f32 v60, v60, v61
    v_cvt_pk_bf16_f32 v61, v62, v63
    v_cvt_pk_bf16_f32 v62, v64, v65
    v_cvt_pk_bf16_f32 v63, v66, v67
    v_cvt_pk_bf16_f32 v64, v68, v69
    v_cvt_pk_bf16_f32 v65, v70, v71
    v_cvt_pk_bf16_f32 v66, v72, v73
    v_cvt_pk_bf16_f32 v67, v74, v75
    s_nop 1
    v_permlane32_swap_b32 v60, v62
    v_permlane32_swap_b32 v61, v63
    v_permlane32_swap_b32 v64, v66
    v_permlane32_swap_b32 v65, v67
    s_add_u32 s77, s76, 0
    buffer_store_dwordx4 v[60:63], v3, s[60:63], s77 offen offset:3072 sc1
    buffer_store_dwordx4 v[64:67], v3, s[60:63], s77 offen offset:3584 sc1
    v_cvt_pk_bf16_f32 v128, v128, v129
    v_cvt_pk_bf16_f32 v129, v130, v131
    v_cvt_pk_bf16_f32 v130, v132, v133
    v_cvt_pk_bf16_f32 v131, v134, v135
    v_cvt_pk_bf16_f32 v132, v136, v137
    v_cvt_pk_bf16_f32 v133, v138, v139
    v_cvt_pk_bf16_f32 v134, v140, v141
    v_cvt_pk_bf16_f32 v135, v142, v143
    s_nop 1
    v_permlane32_swap_b32 v128, v130
    v_permlane32_swap_b32 v129, v131
    v_permlane32_swap_b32 v132, v134
    v_permlane32_swap_b32 v133, v135
    s_add_u32 s77, s76, 262144
    buffer_store_dwordx4 v[128:131], v3, s[60:63], s77 offen offset:1024 sc1
    buffer_store_dwordx4 v[132:135], v3, s[60:63], s77 offen offset:1536 sc1
    v_cvt_pk_bf16_f32 v144, v144, v145
    v_cvt_pk_bf16_f32 v145, v146, v147
    v_cvt_pk_bf16_f32 v146, v148, v149
    v_cvt_pk_bf16_f32 v147, v150, v151
    v_cvt_pk_bf16_f32 v148, v152, v153
    v_cvt_pk_bf16_f32 v149, v154, v155
    v_cvt_pk_bf16_f32 v150, v156, v157
    v_cvt_pk_bf16_f32 v151, v158, v159
    s_nop 1
    v_permlane32_swap_b32 v144, v146
    v_permlane32_swap_b32 v145, v147
    v_permlane32_swap_b32 v148, v150
    v_permlane32_swap_b32 v149, v151
    s_add_u32 s77, s76, 262144
    buffer_store_dwordx4 v[144:147], v3, s[60:63], s77 offen offset:3072 sc1
    buffer_store_dwordx4 v[148:151], v3, s[60:63], s77 offen offset:3584 sc1
L_A_B8:
    s_cmp_lt_u32 s68, 4
    s_cbranch_scc1 L_A_KP
    s_setprio 0
L_A_KP:
    s_and_b32 s73, s68, 2
    s_lshr_b32 s74, s68, 2
    s_add_u32 s73, s73, s74
    s_lshl_b32 s73, s73, 11
    s_and_b32 s74, s68, 1
    s_lshl_b32 s74, s74, 10
    s_add_u32 s73, s73, s74
    s_add_u32 s73, s73, 0
    v_add_u32 v2, s73, v6
    v_xor_b32 v3, 0x800, v2
    v_add_u32 v120, 131072, v9
    v_add_u32 v121, 131072, v10
    s_and_b32 s74, s68, 3
    s_mul_i32 s73, s74, 4608
    s_add_u32 s73, s73, 131072
    v_add_u32 v122, s73, v6
    v_add_u32 v123, s73, v11
    s_lshl_b32 s74, s74, 2
    s_add_u32 s74, s74, 163456
    v_mov_b32 v124, s74
    s_and_b32 s73, s68, 1
    s_lshl_b32 s74, s69, 1
    s_add_u32 s73, s73, s74
    s_lshl_b32 s73, s73, 7
    s_add_u32 s73, s73, 0x1c000
    v_and_b32 v127, 0x7c, v11
    v_and_b32 v4, 0, v0
    v_lshlrev_b32 v4, 2, v4
    v_add_u32 v4, 163424, v4
    s_mov_b32 s84, 400000
tw_67:
    ds_read_b32 v5, v4
    s_waitcnt lgkmcnt(0)
    v_cmp_ne_u32 vcc, 1, v5
    s_cbranch_vccz twd_68
    s_sub_u32 s84, s84, 1
    s_cbranch_scc1 twd_68
    s_sleep 2
    s_branch tw_67
twd_68:
    buffer_load_dword v126, v127, s[60:63], s73 offen sc1
    ds_read_b32 v4, v1 offset:32372
    s_waitcnt lgkmcnt(0)
    v_readfirstlane_b32 s71, v4
    ds_read_b128 v[20:23], v120 offset:0
    s_mov_b64 exec, s[86:87]
    ds_read_b128 v[28:31], v121 offset:1024
    ds_read_b128 v[32:35], v121 offset:1536
    s_mov_b64 exec, -1
    ds_read_b128 v[24:27], v120 offset:4096
    s_bitcmp1_b32 s68, 1
    s_cbranch_scc0 L_A_WL
    v_and_b32 v4, 0, v0
    v_lshlrev_b32 v4, 2, v4
    v_add_u32 v4, 163428, v4
    s_mov_b32 s84, 400000
tw_69:
    ds_read_b32 v5, v4
    s_waitcnt lgkmcnt(0)
    v_cmp_ne_u32 vcc, 1, v5
    s_cbranch_vccz twd_70
    s_sub_u32 s84, s84, 1
    s_cbranch_scc1 twd_70
    s_sleep 1
    s_branch tw_69
twd_70:
    s_branch L_A_WD
L_A_WL:
    v_and_b32 v4, 0, v0
    v_lshlrev_b32 v4, 2, v4
    v_add_u32 v4, 163392, v4
    s_mov_b32 s84, 400000
tw_71:
    ds_read_b32 v5, v4
    s_waitcnt lgkmcnt(0)
    v_cmp_ne_u32 vcc, 1, v5
    s_cbranch_vccz twd_72
    s_sub_u32 s84, s84, 1
    s_cbranch_scc1 twd_72
    s_sleep 1
    s_branch tw_71
twd_72:
L_A_WD:
    ds_read_b128 v[12:15], v2
    ds_read_b128 v[16:19], v3
    s_setprio 2
    s_waitcnt lgkmcnt(0)
    v_mfma_f32_32x32x16_bf16 v[44:59], v[20:23], v[12:15], 0
    s_nop 11
    s_and_b32 s77, s68, 6
    s_cmp_eq_u32 s77, 2
    s_cselect_b32 s77, 0, 1
    v_exp_f32 v44, v44
    v_exp_f32 v45, v45
    v_exp_f32 v46, v46
    v_exp_f32 v47, v47
    v_exp_f32 v48, v48
    v_mfma_f32_32x32x16_bf16 v[60:75], v[20:23], v[16:19], 0
    v_exp_f32 v49, v49
    v_exp_f32 v50, v50
    v_exp_f32 v51, v51
    v_exp_f32 v52, v52
    v_exp_f32 v53, v53
    s_waitcnt lgkmcnt(1)
    v_exp_f32 v54, v54
    v_smfmac_f32_32x32x32_bf16 v[76:91], v[28:31], v[44:51], v8
    v_exp_f32 v55, v55
    v_exp_f32 v56, v56
    v_exp_f32 v57, v57
    v_exp_f32 v58, v58
    v_exp_f32 v59, v59
    v_exp_f32 v60, v60
    v_exp_f32 v61, v61
    v_smfmac_f32_32x32x32_bf16 v[76:91], v[32:35], v[52:59], v8
    s_mov_b64 exec, s[86:87]
    ds_read_b128 v[36:39], v121 offset:5120
    ds_read_b128 v[40:43], v121 offset:5632
    s_mov_b64 exec, -1
    v_exp_f32 v62, v62
    v_exp_f32 v63, v63
    v_exp_f32 v64, v64
    s_waitcnt lgkmcnt(2)
    v_mfma_f32_32x32x16_bf16 v[44:59], v[24:27], v[12:15], 0
    ds_read_b128 v[20:23], v120 offset:8192
    v_exp_f32 v65, v65
    v_exp_f32 v66, v66
    v_exp_f32 v67, v67
    v_exp_f32 v68, v68
    v_exp_f32 v69, v69
    v_exp_f32 v70, v70
    v_smfmac_f32_32x32x32_bf16 v[92:107], v[28:31], v[60:67], v8
    v_exp_f32 v71, v71
    v_exp_f32 v72, v72
    v_exp_f32 v73, v73
    v_exp_f32 v74, v74
    v_exp_f32 v75, v75
    s_cmp_eq_u32 s77, 0
    s_cbranch_scc0 fl_73
    s_getreg_b32 s72, hwreg(HW_REG_IB_STS, 0, 4)
    s_cmp_eq_u32 s72, 0
    s_cbranch_scc0 fl_73
    s_waitcnt vmcnt(0)
    s_mov_b32 s77, 1
    v_mov_b32 v2, s71
    s_mov_b64 exec, 1
    buffer_store_dword v2, off, s[60:63], s78 sc1
    s_mov_b64 exec, -1
fl_73:
    v_exp_f32 v44, v44
    v_exp_f32 v45, v45
    v_smfmac_f32_32x32x32_bf16 v[92:107], v[32:35], v[68:75], v8
    v_exp_f32 v46, v46
    v_exp_f32 v47, v47
    v_exp_f32 v48, v48
    v_mfma_f32_32x32x16_bf16 v[60:75], v[24:27], v[16:19], 0
    v_exp_f32 v49, v49
    v_exp_f32 v50, v50
    v_exp_f32 v51, v51
    v_exp_f32 v52, v52
    v_exp_f32 v53, v53
    s_waitcnt lgkmcnt(1)
    v_exp_f32 v54, v54
    v_smfmac_f32_32x32x32_bf16 v[76:91], v[36:39], v[44:51], v8
    v_exp_f32 v55, v55
    v_exp_f32 v56, v56
    v_exp_f32 v57, v57
    v_exp_f32 v58, v58
    v_exp_f32 v59, v59
    v_exp_f32 v60, v60
    v_exp_f32 v61, v61
    v_smfmac_f32_32x32x32_bf16 v[76:91], v[40:43], v[52:59], v8
    s_mov_b64 exec, s[86:87]
    ds_read_b128 v[28:31], v121 offset:9216
    ds_read_b128 v[32:35], v121 offset:9728
    s_mov_b64 exec, -1
    v_exp_f32 v62, v62
    v_exp_f32 v63, v63
    v_exp_f32 v64, v64
    s_waitcnt lgkmcnt(2)
    v_mfma_f32_32x32x16_bf16 v[44:59], v[20:23], v[12:15], 0
    ds_read_b128 v[24:27], v120 offset:12288
    v_exp_f32 v65, v65
    v_exp_f32 v66, v66
    v_exp_f32 v67, v67
    v_exp_f32 v68, v68
    v_exp_f32 v69, v69
    v_exp_f32 v70, v70
    v_smfmac_f32_32x32x32_bf16 v[92:107], v[36:39], v[60:67], v8
    v_exp_f32 v71, v71
    v_exp_f32 v72, v72
    v_exp_f32 v73, v73
    v_exp_f32 v74, v74
    v_exp_f32 v75, v75
    s_waitcnt lgkmcnt(0)
    v_and_b32 v2, 0, v0
    v_lshlrev_b32 v2, 2, v2
    v_add_u32 v2, 163400, v2
    s_mov_b32 s84, 400000
tw_74:
    ds_read_b32 v3, v2
    s_waitcnt lgkmcnt(0)
    v_cmp_ne_u32 vcc, 1, v3
    s_cbranch_vccz twd_75
    s_sub_u32 s84, s84, 1
    s_cbranch_scc1 twd_75
    s_branch tw_74
twd_75:
    s_cmp_eq_u32 s77, 0
    s_cbranch_scc0 fl_76
    s_getreg_b32 s72, hwreg(HW_REG_IB_STS, 0, 4)
    s_cmp_eq_u32 s72, 0
    s_cbranch_scc0 fl_76
    s_waitcnt vmcnt(0)
    s_mov_b32 s77, 1
    v_mov_b32 v2, s71
    s_mov_b64 exec, 1
    buffer_store_dword v2, off, s[60:63], s78 sc1
    s_mov_b64 exec, -1
fl_76:
    v_exp_f32 v44, v44
    v_exp_f32 v45, v45
    v_smfmac_f32_32x32x32_bf16 v[92:107], v[40:43], v[68:75], v8
    v_exp_f32 v46, v46
    v_exp_f32 v47, v47
    v_exp_f32 v48, v48
    v_mfma_f32_32x32x16_bf16 v[60:75], v[20:23], v[16:19], 0
    v_exp_f32 v49, v49
    v_exp_f32 v50, v50
    v_exp_f32 v51, v51
    v_exp_f32 v52, v52
    v_exp_f32 v53, v53
    s_waitcnt lgkmcnt(1)
    v_exp_f32 v54, v54
    v_smfmac_f32_32x32x32_bf16 v[76:91], v[28:31], v[44:51], v8
    v_exp_f32 v55, v55
    v_exp_f32 v56, v56
    v_exp_f32 v57, v57
    v_exp_f32 v58, v58
    v_exp_f32 v59, v59
    v_exp_f32 v60, v60
    v_exp_f32 v61, v61
    v_smfmac_f32_32x32x32_bf16 v[76:91], v[32:35], v[52:59], v8
    s_mov_b64 exec, s[86:87]
    ds_read_b128 v[36:39], v121 offset:13312
    ds_read_b128 v[40:43], v121 offset:13824
    s_mov_b64 exec, -1
    v_exp_f32 v62, v62
    v_exp_f32 v63, v63
    v_exp_f32 v64, v64
    s_waitcnt lgkmcnt(2)
    v_mfma_f32_32x32x16_bf16 v[44:59], v[24:27], v[12:15], 0
    ds_read_b128 v[20:23], v9 offset:32768
    v_exp_f32 v65, v65
    v_exp_f32 v66, v66
    v_exp_f32 v67, v67
    v_exp_f32 v68, v68
    v_exp_f32 v69, v69
    v_exp_f32 v70, v70
    v_smfmac_f32_32x32x32_bf16 v[92:107], v[28:31], v[60:67], v8
    v_exp_f32 v71, v71
    v_exp_f32 v72, v72
    v_exp_f32 v73, v73
    v_exp_f32 v74, v74
    v_exp_f32 v75, v75
    s_cmp_eq_u32 s77, 0
    s_cbranch_scc0 fl_77
    s_getreg_b32 s72, hwreg(HW_REG_IB_STS, 0, 4)
    s_cmp_eq_u32 s72, 0
    s_cbranch_scc0 fl_77
    s_waitcnt vmcnt(0)
    s_mov_b32 s77, 1
    v_mov_b32 v2, s71
    s_mov_b64 exec, 1
    buffer_store_dword v2, off, s[60:63], s78 sc1
    s_mov_b64 exec, -1
fl_77:
    v_exp_f32 v44, v44
    v_exp_f32 v45, v45
    v_smfmac_f32_32x32x32_bf16 v[92:107], v[32:35], v[68:75], v8
    v_exp_f32 v46, v46
    v_exp_f32 v47, v47
    v_exp_f32 v48, v48
    v_mfma_f32_32x32x16_bf16 v[60:75], v[24:27], v[16:19], 0
    v_exp_f32 v49, v49
    v_exp_f32 v50, v50
    v_exp_f32 v51, v51
    v_exp_f32 v52, v52
    v_exp_f32 v53, v53
    s_waitcnt lgkmcnt(1)
    v_exp_f32 v54, v54
    v_smfmac_f32_32x32x32_bf16 v[76:91], v[36:39], v[44:51], v8
    v_exp_f32 v55, v55
    v_exp_f32 v56, v56
    v_exp_f32 v57, v57
    v_exp_f32 v58, v58
    v_exp_f32 v59, v59
    v_exp_f32 v60, v60
    v_exp_f32 v61, v61
    v_smfmac_f32_32x32x32_bf16 v[76:91], v[40:43], v[52:59], v8
    s_mov_b64 exec, s[86:87]
    ds_read_b128 v[28:31], v10 offset:33792
    ds_read_b128 v[32:35], v10 offset:34304
    s_mov_b64 exec, -1
    v_exp_f32 v62, v62
    v_exp_f32 v63, v63
    v_exp_f32 v64, v64
    s_waitcnt lgkmcnt(2)
    v_mfma_f32_32x32x16_bf16 v[44:59], v[20:23], v[12:15], 0
    ds_read_b128 v[24:27], v9 offset:36864
    v_exp_f32 v65, v65
    v_exp_f32 v66, v66
    v_exp_f32 v67, v67
    v_exp_f32 v68, v68
    v_exp_f32 v69, v69
    v_exp_f32 v70, v70
    v_smfmac_f32_32x32x32_bf16 v[92:107], v[36:39], v[60:67], v8
    v_exp_f32 v71, v71
    v_exp_f32 v72, v72
    v_exp_f32 v73, v73
    v_exp_f32 v74, v74
    v_exp_f32 v75, v75
    v_exp_f32 v44, v44
    v_exp_f32 v45, v45
    v_smfmac_f32_32x32x32_bf16 v[92:107], v[40:43], v[68:75], v8
    v_exp_f32 v46, v46
    v_exp_f32 v47, v47
    v_exp_f32 v48, v48
    v_mfma_f32_32x32x16_bf16 v[60:75], v[20:23], v[16:19], 0
    v_exp_f32 v49, v49
    v_exp_f32 v50, v50
    v_exp_f32 v51, v51
    v_exp_f32 v52, v52
    v_exp_f32 v53, v53
    s_waitcnt lgkmcnt(1)
    v_exp_f32 v54, v54
    v_smfmac_f32_32x32x32_bf16 v[76:91], v[28:31], v[44:51], v8
    v_exp_f32 v55, v55
    v_exp_f32 v56, v56
    v_exp_f32 v57, v57
    v_exp_f32 v58, v58
    v_exp_f32 v59, v59
    v_exp_f32 v60, v60
    v_exp_f32 v61, v61
    v_smfmac_f32_32x32x32_bf16 v[76:91], v[32:35], v[52:59], v8
    s_mov_b64 exec, s[86:87]
    ds_read_b128 v[36:39], v10 offset:37888
    ds_read_b128 v[40:43], v10 offset:38400
    s_mov_b64 exec, -1
    v_exp_f32 v62, v62
    v_exp_f32 v63, v63
    v_exp_f32 v64, v64
    s_waitcnt lgkmcnt(2)
    v_mfma_f32_32x32x16_bf16 v[44:59], v[24:27], v[12:15], 0
    ds_read_b128 v[20:23], v9 offset:40960
    v_exp_f32 v65, v65
    v_exp_f32 v66, v66
    v_exp_f32 v67, v67
    v_exp_f32 v68, v68
    v_exp_f32 v69, v69
    v_exp_f32 v70, v70
    v_smfmac_f32_32x32x32_bf16 v[92:107], v[28:31], v[60:67], v8
    v_exp_f32 v71, v71
    v_exp_f32 v72, v72
    v_exp_f32 v73, v73
    v_exp_f32 v74, v74
    v_exp_f32 v75, v75
    s_cmp_eq_u32 s77, 0
    s_cbranch_scc0 fl_78
    s_waitcnt vmcnt(0)
    s_mov_b32 s77, 1
    v_mov_b32 v2, s71
    s_mov_b64 exec, 1
    buffer_store_dword v2, off, s[60:63], s78 sc1
    s_mov_b64 exec, -1
fl_78:
    v_exp_f32 v44, v44
    v_exp_f32 v45, v45
    v_smfmac_f32_32x32x32_bf16 v[92:107], v[32:35], v[68:75], v8
    v_exp_f32 v46, v46
    v_exp_f32 v47, v47
    v_exp_f32 v48, v48
    v_mfma_f32_32x32x16_bf16 v[60:75], v[24:27], v[16:19], 0
    v_exp_f32 v49, v49
    v_exp_f32 v50, v50
    v_exp_f32 v51, v51
    v_exp_f32 v52, v52
    v_exp_f32 v53, v53
    s_waitcnt lgkmcnt(1)
    v_exp_f32 v54, v54
    v_smfmac_f32_32x32x32_bf16 v[76:91], v[36:39], v[44:51], v8
    v_exp_f32 v55, v55
    v_exp_f32 v56, v56
    v_exp_f32 v57, v57
    v_exp_f32 v58, v58
    v_exp_f32 v59, v59
    v_exp_f32 v60, v60
    v_exp_f32 v61, v61
    v_smfmac_f32_32x32x32_bf16 v[76:91], v[40:43], v[52:59], v8
    s_mov_b64 exec, s[86:87]
    ds_read_b128 v[28:31], v10 offset:41984
    ds_read_b128 v[32:35], v10 offset:42496
    s_mov_b64 exec, -1
    v_exp_f32 v62, v62
    v_exp_f32 v63, v63
    v_exp_f32 v64, v64
    s_waitcnt lgkmcnt(2)
    v_mfma_f32_32x32x16_bf16 v[44:59], v[20:23], v[12:15], 0
    ds_read_b128 v[24:27], v9 offset:45056
    v_exp_f32 v65, v65
    v_exp_f32 v66, v66
    v_exp_f32 v67, v67
    v_exp_f32 v68, v68
    v_exp_f32 v69, v69
    v_exp_f32 v70, v70
    v_smfmac_f32_32x32x32_bf16 v[92:107], v[36:39], v[60:67], v8
    v_exp_f32 v71, v71
    v_exp_f32 v72, v72
    v_exp_f32 v73, v73
    v_exp_f32 v74, v74
    v_exp_f32 v75, v75
    s_waitcnt lgkmcnt(0)
    v_and_b32 v2, 0, v0
    v_lshlrev_b32 v2, 2, v2
    v_add_u32 v2, 163404, v2
    s_mov_b32 s84, 400000
tw_79:
    ds_read_b32 v3, v2
    s_waitcnt lgkmcnt(0)
    v_cmp_ne_u32 vcc, 1, v3
    s_cbranch_vccz twd_80
    s_sub_u32 s84, s84, 1
    s_cbranch_scc1 twd_80
    s_branch tw_79
twd_80:
    v_exp_f32 v44, v44
    v_exp_f32 v45, v45
    v_smfmac_f32_32x32x32_bf16 v[92:107], v[40:43], v[68:75], v8
    v_exp_f32 v46, v46
    v_exp_f32 v47, v47
    v_exp_f32 v48, v48
    v_mfma_f32_32x32x16_bf16 v[60:75], v[20:23], v[16:19], 0
    v_exp_f32 v49, v49
    v_exp_f32 v50, v50
    v_exp_f32 v51, v51
    v_exp_f32 v52, v52
    v_exp_f32 v53, v53
    s_waitcnt lgkmcnt(1)
    v_exp_f32 v54, v54
    v_smfmac_f32_32x32x32_bf16 v[76:91], v[28:31], v[44:51], v8
    v_exp_f32 v55, v55
    v_exp_f32 v56, v56
    v_exp_f32 v57, v57
    v_exp_f32 v58, v58
    v_exp_f32 v59, v59
    v_exp_f32 v60, v60
    v_exp_f32 v61, v61
    v_smfmac_f32_32x32x32_bf16 v[76:91], v[32:35], v[52:59], v8
    s_mov_b64 exec, s[86:87]
    ds_read_b128 v[36:39], v10 offset:46080
    ds_read_b128 v[40:43], v10 offset:46592
    s_mov_b64 exec, -1
    v_exp_f32 v62, v62
    v_exp_f32 v63, v63
    v_exp_f32 v64, v64
    s_waitcnt lgkmcnt(2)
    v_mfma_f32_32x32x16_bf16 v[44:59], v[24:27], v[12:15], 0
    ds_read_b128 v[20:23], v9 offset:49152
    v_exp_f32 v65, v65
    v_exp_f32 v66, v66
    v_exp_f32 v67, v67
    v_exp_f32 v68, v68
    v_exp_f32 v69, v69
    v_exp_f32 v70, v70
    v_smfmac_f32_32x32x32_bf16 v[92:107], v[28:31], v[60:67], v8
    v_exp_f32 v71, v71
    v_exp_f32 v72, v72
    v_exp_f32 v73, v73
    v_exp_f32 v74, v74
    v_exp_f32 v75, v75
    v_exp_f32 v44, v44
    v_exp_f32 v45, v45
    v_smfmac_f32_32x32x32_bf16 v[92:107], v[32:35], v[68:75], v8
    v_exp_f32 v46, v46
    v_exp_f32 v47, v47
    v_exp_f32 v48, v48
    v_mfma_f32_32x32x16_bf16 v[60:75], v[24:27], v[16:19], 0
    v_exp_f32 v49, v49
    v_exp_f32 v50, v50
    v_exp_f32 v51, v51
    v_exp_f32 v52, v52
    v_exp_f32 v53, v53
    s_waitcnt lgkmcnt(1)
    v_exp_f32 v54, v54
    v_smfmac_f32_32x32x32_bf16 v[76:91], v[36:39], v[44:51], v8
    v_exp_f32 v55, v55
    v_exp_f32 v56, v56
    v_exp_f32 v57, v57
    v_exp_f32 v58, v58
    v_exp_f32 v59, v59
    v_exp_f32 v60, v60
    v_exp_f32 v61, v61
    v_smfmac_f32_32x32x32_bf16 v[76:91], v[40:43], v[52:59], v8
    s_mov_b64 exec, s[86:87]
    ds_read_b128 v[28:31], v10 offset:50176
    ds_read_b128 v[32:35], v10 offset:50688
    s_mov_b64 exec, -1
    v_exp_f32 v62, v62
    v_exp_f32 v63, v63
    v_exp_f32 v64, v64
    s_waitcnt lgkmcnt(2)
    v_mfma_f32_32x32x16_bf16 v[44:59], v[20:23], v[12:15], 0
    ds_read_b128 v[24:27], v9 offset:53248
    v_exp_f32 v65, v65
    v_exp_f32 v66, v66
    v_exp_f32 v67, v67
    v_exp_f32 v68, v68
    v_exp_f32 v69, v69
    v_exp_f32 v70, v70
    v_smfmac_f32_32x32x32_bf16 v[92:107], v[36:39], v[60:67], v8
    v_exp_f32 v71, v71
    v_exp_f32 v72, v72
    v_exp_f32 v73, v73
    v_exp_f32 v74, v74
    v_exp_f32 v75, v75
    v_exp_f32 v44, v44
    v_exp_f32 v45, v45
    v_smfmac_f32_32x32x32_bf16 v[92:107], v[40:43], v[68:75], v8
    v_exp_f32 v46, v46
    v_exp_f32 v47, v47
    v_exp_f32 v48, v48
    v_mfma_f32_32x32x16_bf16 v[60:75], v[20:23], v[16:19], 0
    v_exp_f32 v49, v49
    v_exp_f32 v50, v50
    v_exp_f32 v51, v51
    v_exp_f32 v52, v52
    v_exp_f32 v53, v53
    s_waitcnt lgkmcnt(1)
    v_exp_f32 v54, v54
    v_smfmac_f32_32x32x32_bf16 v[76:91], v[28:31], v[44:51], v8
    v_exp_f32 v55, v55
    v_exp_f32 v56, v56
    v_exp_f32 v57, v57
    v_exp_f32 v58, v58
    v_exp_f32 v59, v59
    v_exp_f32 v60, v60
    v_exp_f32 v61, v61
    v_smfmac_f32_32x32x32_bf16 v[76:91], v[32:35], v[52:59], v8
    s_mov_b64 exec, s[86:87]
    ds_read_b128 v[36:39], v10 offset:54272
    ds_read_b128 v[40:43], v10 offset:54784
    s_mov_b64 exec, -1
    v_exp_f32 v62, v62
    v_exp_f32 v63, v63
    v_exp_f32 v64, v64
    s_waitcnt lgkmcnt(2)
    v_mfma_f32_32x32x16_bf16 v[44:59], v[24:27], v[12:15], 0
    ds_read_b128 v[20:23], v9 offset:57344
    v_exp_f32 v65, v65
    v_exp_f32 v66, v66
    v_exp_f32 v67, v67
    v_exp_f32 v68, v68
    v_exp_f32 v69, v69
    v_exp_f32 v70, v70
    v_smfmac_f32_32x32x32_bf16 v[92:107], v[28:31], v[60:67], v8
    v_exp_f32 v71, v71
    v_exp_f32 v72, v72
    v_exp_f32 v73, v73
    v_exp_f32 v74, v74
    v_exp_f32 v75, v75
    v_exp_f32 v44, v44
    v_exp_f32 v45, v45
    v_smfmac_f32_32x32x32_bf16 v[92:107], v[32:35], v[68:75], v8
    v_exp_f32 v46, v46
    v_exp_f32 v47, v47
    v_exp_f32 v48, v48
    v_mfma_f32_32x32x16_bf16 v[60:75], v[24:27], v[16:19], 0
    v_exp_f32 v49, v49
    v_exp_f32 v50, v50
    v_exp_f32 v51, v51
    v_exp_f32 v52, v52
    v_exp_f32 v53, v53
    s_waitcnt lgkmcnt(1)
    v_exp_f32 v54, v54
    v_smfmac_f32_32x32x32_bf16 v[76:91], v[36:39], v[44:51], v8
    v_exp_f32 v55, v55
    v_exp_f32 v56, v56
    v_exp_f32 v57, v57
    v_exp_f32 v58, v58
    v_exp_f32 v59, v59
    v_exp_f32 v60, v60
    v_exp_f32 v61, v61
    v_smfmac_f32_32x32x32_bf16 v[76:91], v[40:43], v[52:59], v8
    s_mov_b64 exec, s[86:87]
    ds_read_b128 v[28:31], v10 offset:58368
    ds_read_b128 v[32:35], v10 offset:58880
    s_mov_b64 exec, -1
    v_exp_f32 v62, v62
    v_exp_f32 v63, v63
    v_exp_f32 v64, v64
    s_waitcnt lgkmcnt(2)
    v_mfma_f32_32x32x16_bf16 v[44:59], v[20:23], v[12:15], 0
    ds_read_b128 v[24:27], v9 offset:61440
    v_exp_f32 v65, v65
    v_exp_f32 v66, v66
    v_exp_f32 v67, v67
    v_exp_f32 v68, v68
    v_exp_f32 v69, v69
    v_exp_f32 v70, v70
    v_smfmac_f32_32x32x32_bf16 v[92:107], v[36:39], v[60:67], v8
    v_exp_f32 v71, v71
    v_exp_f32 v72, v72
    v_exp_f32 v73, v73
    v_exp_f32 v74, v74
    v_exp_f32 v75, v75
    s_waitcnt lgkmcnt(0)
    v_and_b32 v2, 0, v0
    v_lshlrev_b32 v2, 2, v2
    v_add_u32 v2, 163396, v2
    s_mov_b32 s84, 400000
tw_81:
    ds_read_b32 v3, v2
    s_waitcnt lgkmcnt(0)
    v_cmp_ne_u32 vcc, 1, v3
    s_cbranch_vccz twd_82
    s_sub_u32 s84, s84, 1
    s_cbranch_scc1 twd_82
    s_branch tw_81
twd_82:
    v_exp_f32 v44, v44
    v_exp_f32 v45, v45
    v_smfmac_f32_32x32x32_bf16 v[92:107], v[40:43], v[68:75], v8
    v_exp_f32 v46, v46
    v_exp_f32 v47, v47
    v_exp_f32 v48, v48
    v_mfma_f32_32x32x16_bf16 v[60:75], v[20:23], v[16:19], 0
    v_exp_f32 v49, v49
    v_exp_f32 v50, v50
    v_exp_f32 v51, v51
    v_exp_f32 v52, v52
    v_exp_f32 v53, v53
    s_waitcnt lgkmcnt(1)
    v_exp_f32 v54, v54
    v_smfmac_f32_32x32x32_bf16 v[76:91], v[28:31], v[44:51], v8
    v_exp_f32 v55, v55
    v_exp_f32 v56, v56
    v_exp_f32 v57, v57
    v_exp_f32 v58, v58
    v_exp_f32 v59, v59
    v_exp_f32 v60, v60
    v_exp_f32 v61, v61
    v_smfmac_f32_32x32x32_bf16 v[76:91], v[32:35], v[52:59], v8
    s_mov_b64 exec, s[86:87]
    ds_read_b128 v[36:39], v10 offset:62464
    ds_read_b128 v[40:43], v10 offset:62976
    s_mov_b64 exec, -1
    v_exp_f32 v62, v62
    v_exp_f32 v63, v63
    v_exp_f32 v64, v64
    s_waitcnt lgkmcnt(2)
    v_mfma_f32_32x32x16_bf16 v[44:59], v[24:27], v[12:15], 0
    ds_read_b128 v[20:23], v9 offset:16384
    v_exp_f32 v65, v65
    v_exp_f32 v66, v66
    v_exp_f32 v67, v67
    v_exp_f32 v68, v68
    v_exp_f32 v69, v69
    v_exp_f32 v70, v70
    v_smfmac_f32_32x32x32_bf16 v[92:107], v[28:31], v[60:67], v8
    v_exp_f32 v71, v71
    v_exp_f32 v72, v72
    v_exp_f32 v73, v73
    v_exp_f32 v74, v74
    v_exp_f32 v75, v75
    v_exp_f32 v44, v44
    v_exp_f32 v45, v45
    v_smfmac_f32_32x32x32_bf16 v[92:107], v[32:35], v[68:75], v8
    v_exp_f32 v46, v46
    v_exp_f32 v47, v47
    v_exp_f32 v48, v48
    v_mfma_f32_32x32x16_bf16 v[60:75], v[24:27], v[16:19], 0
    v_exp_f32 v49, v49
    v_exp_f32 v50, v50
    v_exp_f32 v51, v51
    v_exp_f32 v52, v52
    v_exp_f32 v53, v53
    s_waitcnt lgkmcnt(1)
    v_exp_f32 v54, v54
    v_smfmac_f32_32x32x32_bf16 v[76:91], v[36:39], v[44:51], v8
    v_exp_f32 v55, v55
    v_exp_f32 v56, v56
    v_exp_f32 v57, v57
    v_exp_f32 v58, v58
    v_exp_f32 v59, v59
    v_exp_f32 v60, v60
    v_exp_f32 v61, v61
    v_smfmac_f32_32x32x32_bf16 v[76:91], v[40:43], v[52:59], v8
    s_mov_b64 exec, s[86:87]
    ds_read_b128 v[28:31], v10 offset:17408
    ds_read_b128 v[32:35], v10 offset:17920
    s_mov_b64 exec, -1
    v_exp_f32 v62, v62
    v_exp_f32 v63, v63
    v_exp_f32 v64, v64
    s_waitcnt lgkmcnt(2)
    v_mfma_f32_32x32x16_bf16 v[44:59], v[20:23], v[12:15], 0
    ds_read_b128 v[24:27], v9 offset:20480
    v_exp_f32 v65, v65
    v_exp_f32 v66, v66
    v_exp_f32 v67, v67
    v_exp_f32 v68, v68
    v_exp_f32 v69, v69
    v_exp_f32 v70, v70
    v_smfmac_f32_32x32x32_bf16 v[92:107], v[36:39], v[60:67], v8
    v_exp_f32 v71, v71
    v_exp_f32 v72, v72
    v_exp_f32 v73, v73
    v_exp_f32 v74, v74
    v_exp_f32 v75, v75
    v_exp_f32 v44, v44
    v_exp_f32 v45, v45
    v_smfmac_f32_32x32x32_bf16 v[92:107], v[40:43], v[68:75], v8
    v_exp_f32 v46, v46
    v_exp_f32 v47, v47
    v_exp_f32 v48, v48
    v_mfma_f32_32x32x16_bf16 v[60:75], v[20:23], v[16:19], 0
    v_exp_f32 v49, v49
    v_exp_f32 v50, v50
    v_exp_f32 v51, v51
    v_exp_f32 v52, v52
    v_exp_f32 v53, v53
    s_waitcnt lgkmcnt(1)
    v_exp_f32 v54, v54
    v_smfmac_f32_32x32x32_bf16 v[76:91], v[28:31], v[44:51], v8
    v_exp_f32 v55, v55
    v_exp_f32 v56, v56
    v_exp_f32 v57, v57
    v_exp_f32 v58, v58
    v_exp_f32 v59, v59
    v_exp_f32 v60, v60
    v_exp_f32 v61, v61
    v_smfmac_f32_32x32x32_bf16 v[76:91], v[32:35], v[52:59], v8
    s_mov_b64 exec, s[86:87]
    ds_read_b128 v[36:39], v10 offset:21504
    ds_read_b128 v[40:43], v10 offset:22016
    s_mov_b64 exec, -1
    v_exp_f32 v62, v62
    v_exp_f32 v63, v63
    v_exp_f32 v64, v64
    s_waitcnt lgkmcnt(2)
    v_mfma_f32_32x32x16_bf16 v[44:59], v[24:27], v[12:15], 0
    ds_read_b128 v[20:23], v9 offset:24576
    v_exp_f32 v65, v65
    v_exp_f32 v66, v66
    v_exp_f32 v67, v67
    v_exp_f32 v68, v68
    v_exp_f32 v69, v69
    v_exp_f32 v70, v70
    v_smfmac_f32_32x32x32_bf16 v[92:107], v[28:31], v[60:67], v8
    v_exp_f32 v71, v71
    v_exp_f32 v72, v72
    v_exp_f32 v73, v73
    v_exp_f32 v74, v74
    v_exp_f32 v75, v75
    v_exp_f32 v44, v44
    v_exp_f32 v45, v45
    v_smfmac_f32_32x32x32_bf16 v[92:107], v[32:35], v[68:75], v8
    v_exp_f32 v46, v46
    v_exp_f32 v47, v47
    v_exp_f32 v48, v48
    v_mfma_f32_32x32x16_bf16 v[60:75], v[24:27], v[16:19], 0
    v_exp_f32 v49, v49
    v_exp_f32 v50, v50
    v_exp_f32 v51, v51
    v_exp_f32 v52, v52
    v_exp_f32 v53, v53
    s_waitcnt lgkmcnt(1)
    v_exp_f32 v54, v54
    v_smfmac_f32_32x32x32_bf16 v[76:91], v[36:39], v[44:51], v8
    v_exp_f32 v55, v55
    v_exp_f32 v56, v56
    v_exp_f32 v57, v57
    v_exp_f32 v58, v58
    v_exp_f32 v59, v59
    v_exp_f32 v60, v60
    v_exp_f32 v61, v61
    v_smfmac_f32_32x32x32_bf16 v[76:91], v[40:43], v[52:59], v8
    s_mov_b64 exec, s[86:87]
    ds_read_b128 v[28:31], v10 offset:25600
    ds_read_b128 v[32:35], v10 offset:26112
    s_mov_b64 exec, -1
    v_exp_f32 v62, v62
    v_exp_f32 v63, v63
    v_exp_f32 v64, v64
    s_waitcnt lgkmcnt(2)
    v_mfma_f32_32x32x16_bf16 v[44:59], v[20:23], v[12:15], 0
    ds_read_b128 v[24:27], v9 offset:28672
    v_exp_f32 v65, v65
    v_exp_f32 v66, v66
    v_exp_f32 v67, v67
    v_exp_f32 v68, v68
    v_exp_f32 v69, v69
    v_exp_f32 v70, v70
    v_smfmac_f32_32x32x32_bf16 v[92:107], v[36:39], v[60:67], v8
    v_exp_f32 v71, v71
    v_exp_f32 v72, v72
    v_exp_f32 v73, v73
    v_exp_f32 v74, v74
    v_exp_f32 v75, v75
    s_waitcnt lgkmcnt(0)
    s_mov_b32 s84, 400000
spin_83:
    ds_read_b32 v2, v1 offset:32016
    s_waitcnt lgkmcnt(0)
    v_readfirstlane_b32 s72, v2
    s_cmp_eq_u32 s72, 0x404
    s_cbranch_scc1 spind_84
    s_sub_u32 s84, s84, 1
    s_cbranch_scc1 spind_84
    s_sleep 1
    s_branch spin_83
spind_84:
    v_exp_f32 v44, v44
    v_exp_f32 v45, v45
    v_smfmac_f32_32x32x32_bf16 v[92:107], v[40:43], v[68:75], v8
    v_exp_f32 v46, v46
    v_exp_f32 v47, v47
    v_exp_f32 v48, v48
    v_mfma_f32_32x32x16_bf16 v[60:75], v[20:23], v[16:19], 0
    v_exp_f32 v49, v49
    v_exp_f32 v50, v50
    v_exp_f32 v51, v51
    v_exp_f32 v52, v52
    v_exp_f32 v53, v53
    s_waitcnt lgkmcnt(1)
    v_exp_f32 v54, v54
    v_smfmac_f32_32x32x32_bf16 v[76:91], v[28:31], v[44:51], v8
    v_exp_f32 v55, v55
    v_exp_f32 v56, v56
    v_exp_f32 v57, v57
    v_exp_f32 v58, v58
    v_exp_f32 v59, v59
    v_exp_f32 v60, v60
    v_exp_f32 v61, v61
    v_smfmac_f32_32x32x32_bf16 v[76:91], v[32:35], v[52:59], v8
    s_mov_b64 exec, s[86:87]
    ds_read_b128 v[36:39], v10 offset:29696
    ds_read_b128 v[40:43], v10 offset:30208
    s_mov_b64 exec, -1
    v_exp_f32 v62, v62
    v_exp_f32 v63, v63
    v_exp_f32 v64, v64
    s_waitcnt lgkmcnt(2)
    v_mfma_f32_32x32x16_bf16 v[44:59], v[24:27], v[12:15], 0
    v_add_u32 v9, 0x10000, v9
    ds_read_b128 v[20:23], v9 offset:0
    v_exp_f32 v65, v65
    v_exp_f32 v66, v66
    v_exp_f32 v67, v67
    v_exp_f32 v68, v68
    v_exp_f32 v69, v69
    v_exp_f32 v70, v70
    v_smfmac_f32_32x32x32_bf16 v[92:107], v[28:31], v[60:67], v8
    v_exp_f32 v71, v71
    v_exp_f32 v72, v72
    v_exp_f32 v73, v73
    v_exp_f32 v74, v74
    v_exp_f32 v75, v75
    v_exp_f32 v44, v44
    v_exp_f32 v45, v45
    v_smfmac_f32_32x32x32_bf16 v[92:107], v[32:35], v[68:75], v8
    v_exp_f32 v46, v46
    v_exp_f32 v47, v47
    v_exp_f32 v48, v48
    v_mfma_f32_32x32x16_bf16 v[60:75], v[24:27], v[16:19], 0
    v_exp_f32 v49, v49
    v_exp_f32 v50, v50
    v_exp_f32 v51, v51
    v_exp_f32 v52, v52
    v_exp_f32 v53, v53
    s_waitcnt lgkmcnt(1)
    v_exp_f32 v54, v54
    v_smfmac_f32_32x32x32_bf16 v[76:91], v[36:39], v[44:51], v8
    v_exp_f32 v55, v55
    v_exp_f32 v56, v56
    v_exp_f32 v57, v57
    v_exp_f32 v58, v58
    v_exp_f32 v59, v59
    v_exp_f32 v60, v60
    v_exp_f32 v61, v61
    v_smfmac_f32_32x32x32_bf16 v[76:91], v[40:43], v[52:59], v8
    v_add_u32 v10, 0x10000, v10
    s_mov_b64 exec, s[86:87]
    ds_read_b128 v[28:31], v10 offset:1024
    ds_read_b128 v[32:35], v10 offset:1536
    s_mov_b64 exec, -1
    v_exp_f32 v62, v62
    v_exp_f32 v63, v63
    v_exp_f32 v64, v64
    s_waitcnt lgkmcnt(2)
    v_mfma_f32_32x32x16_bf16 v[44:59], v[20:23], v[12:15], 0
    ds_read_b128 v[24:27], v9 offset:4096
    v_exp_f32 v65, v65
    v_exp_f32 v66, v66
    v_exp_f32 v67, v67
    v_exp_f32 v68, v68
    v_exp_f32 v69, v69
    v_exp_f32 v70, v70
    v_smfmac_f32_32x32x32_bf16 v[92:107], v[36:39], v[60:67], v8
    v_exp_f32 v71, v71
    v_exp_f32 v72, v72
    v_exp_f32 v73, v73
    v_exp_f32 v74, v74
    v_exp_f32 v75, v75
    s_setprio 1
    v_mov_b32 v2, 1
    s_mov_b64 exec, 1
    ds_add_u32 v1, v2 offset:32024
    s_mov_b64 exec, -1
    v_exp_f32 v44, v44
    v_exp_f32 v45, v45
    v_smfmac_f32_32x32x32_bf16 v[92:107], v[40:43], v[68:75], v8
    v_exp_f32 v46, v46
    v_exp_f32 v47, v47
    v_exp_f32 v48, v48
    v_mfma_f32_32x32x16_bf16 v[60:75], v[20:23], v[16:19], 0
    v_exp_f32 v49, v49
    v_exp_f32 v50, v50
    v_exp_f32 v51, v51
    v_exp_f32 v52, v52
    v_exp_f32 v53, v53
    s_waitcnt lgkmcnt(2)
    v_exp_f32 v54, v54
    v_smfmac_f32_32x32x32_bf16 v[76:91], v[28:31], v[44:51], v8
    v_exp_f32 v55, v55
    v_exp_f32 v56, v56
    v_exp_f32 v57, v57
    v_exp_f32 v58, v58
    v_exp_f32 v59, v59
    v_exp_f32 v60, v60
    v_exp_f32 v61, v61
    v_smfmac_f32_32x32x32_bf16 v[76:91], v[32:35], v[52:59], v8
    s_mov_b64 exec, s[86:87]
    ds_read_b128 v[36:39], v10 offset:5120
    ds_read_b128 v[40:43], v10 offset:5632
    s_mov_b64 exec, -1
    v_exp_f32 v62, v62
    v_exp_f32 v63, v63
    v_exp_f32 v64, v64
    s_waitcnt lgkmcnt(2)
    v_mfma_f32_32x32x16_bf16 v[44:59], v[24:27], v[12:15], 0
    ds_read_b128 v[20:23], v9 offset:8192
    v_exp_f32 v65, v65
    v_exp_f32 v66, v66
    v_exp_f32 v67, v67
    v_exp_f32 v68, v68
    v_exp_f32 v69, v69
    v_exp_f32 v70, v70
    v_smfmac_f32_32x32x32_bf16 v[92:107], v[28:31], v[60:67], v8
    v_exp_f32 v71, v71
    v_exp_f32 v72, v72
    v_exp_f32 v73, v73
    v_exp_f32 v74, v74
    v_exp_f32 v75, v75
    v_exp_f32 v44, v44
    v_exp_f32 v45, v45
    v_smfmac_f32_32x32x32_bf16 v[92:107], v[32:35], v[68:75], v8
    v_exp_f32 v46, v46
    v_exp_f32 v47, v47
    v_exp_f32 v48, v48
    v_mfma_f32_32x32x16_bf16 v[60:75], v[24:27], v[16:19], 0
    v_exp_f32 v49, v49
    v_exp_f32 v50, v50
    v_exp_f32 v51, v51
    v_exp_f32 v52, v52
    v_exp_f32 v53, v53
    s_waitcnt lgkmcnt(1)
    v_exp_f32 v54, v54
    v_smfmac_f32_32x32x32_bf16 v[76:91], v[36:39], v[44:51], v8
    v_exp_f32 v55, v55
    v_exp_f32 v56, v56
    v_exp_f32 v57, v57
    v_exp_f32 v58, v58
    v_exp_f32 v59, v59
    v_exp_f32 v60, v60
    v_exp_f32 v61, v61
    v_smfmac_f32_32x32x32_bf16 v[76:91], v[40:43], v[52:59], v8
    s_mov_b64 exec, s[86:87]
    ds_read_b128 v[28:31], v10 offset:9216
    ds_read_b128 v[32:35], v10 offset:9728
    s_mov_b64 exec, -1
    v_exp_f32 v62, v62
    v_exp_f32 v63, v63
    v_exp_f32 v64, v64
    s_waitcnt lgkmcnt(2)
    v_mfma_f32_32x32x16_bf16 v[44:59], v[20:23], v[12:15], 0
    ds_read_b128 v[24:27], v9 offset:12288
    v_exp_f32 v65, v65
    v_exp_f32 v66, v66
    v_exp_f32 v67, v67
    v_exp_f32 v68, v68
    v_exp_f32 v69, v69
    v_exp_f32 v70, v70
    v_smfmac_f32_32x32x32_bf16 v[92:107], v[36:39], v[60:67], v8
    v_exp_f32 v71, v71
    v_exp_f32 v72, v72
    v_exp_f32 v73, v73
    v_exp_f32 v74, v74
    v_exp_f32 v75, v75
    v_exp_f32 v44, v44
    v_exp_f32 v45, v45
    v_smfmac_f32_32x32x32_bf16 v[92:107], v[40:43], v[68:75], v8
    v_exp_f32 v46, v46
    v_exp_f32 v47, v47
    v_exp_f32 v48, v48
    v_mfma_f32_32x32x16_bf16 v[60:75], v[20:23], v[16:19], 0
    v_exp_f32 v49, v49
    v_exp_f32 v50, v50
    v_exp_f32 v51, v51
    v_exp_f32 v52, v52
    v_exp_f32 v53, v53
    s_waitcnt lgkmcnt(1)
    v_exp_f32 v54, v54
    v_smfmac_f32_32x32x32_bf16 v[76:91], v[28:31], v[44:51], v8
    v_exp_f32 v55, v55
    v_exp_f32 v56, v56
    v_exp_f32 v57, v57
    v_exp_f32 v58, v58
    v_exp_f32 v59, v59
    v_exp_f32 v60, v60
    v_exp_f32 v61, v61
    v_smfmac_f32_32x32x32_bf16 v[76:91], v[32:35], v[52:59], v8
    s_mov_b64 exec, s[86:87]
    ds_read_b128 v[36:39], v10 offset:13312
    ds_read_b128 v[40:43], v10 offset:13824
    s_mov_b64 exec, -1
    v_exp_f32 v62, v62
    v_exp_f32 v63, v63
    v_exp_f32 v64, v64
    s_waitcnt lgkmcnt(2)
    v_mfma_f32_32x32x16_bf16 v[44:59], v[24:27], v[12:15], 0
    ds_read_b128 v[20:23], v9 offset:16384
    v_exp_f32 v65, v65
    v_exp_f32 v66, v66
    v_exp_f32 v67, v67
    v_exp_f32 v68, v68
    v_exp_f32 v69, v69
    v_exp_f32 v70, v70
    v_smfmac_f32_32x32x32_bf16 v[92:107], v[28:31], v[60:67], v8
    v_exp_f32 v71, v71
    v_exp_f32 v72, v72
    v_exp_f32 v73, v73
    v_exp_f32 v74, v74
    v_exp_f32 v75, v75
    v_exp_f32 v44, v44
    v_exp_f32 v45, v45
    v_smfmac_f32_32x32x32_bf16 v[92:107], v[32:35], v[68:75], v8
    v_exp_f32 v46, v46
    v_exp_f32 v47, v47
    v_exp_f32 v48, v48
    v_mfma_f32_32x32x16_bf16 v[60:75], v[24:27], v[16:19], 0
    v_exp_f32 v49, v49
    v_exp_f32 v50, v50
    v_exp_f32 v51, v51
    v_exp_f32 v52, v52
    v_exp_f32 v53, v53
    s_waitcnt lgkmcnt(1)
    v_exp_f32 v54, v54
    v_smfmac_f32_32x32x32_bf16 v[76:91], v[36:39], v[44:51], v8
    v_exp_f32 v55, v55
    v_exp_f32 v56, v56
    v_exp_f32 v57, v57
    v_exp_f32 v58, v58
    v_exp_f32 v59, v59
    v_exp_f32 v60, v60
    v_exp_f32 v61, v61
    v_smfmac_f32_32x32x32_bf16 v[76:91], v[40:43], v[52:59], v8
    s_mov_b64 exec, s[86:87]
    ds_read_b128 v[28:31], v10 offset:17408
    ds_read_b128 v[32:35], v10 offset:17920
    s_mov_b64 exec, -1
    v_exp_f32 v62, v62
    v_exp_f32 v63, v63
    v_exp_f32 v64, v64
    s_waitcnt lgkmcnt(2)
    v_mfma_f32_32x32x16_bf16 v[44:59], v[20:23], v[12:15], 0
    ds_read_b128 v[24:27], v9 offset:20480
    v_exp_f32 v65, v65
    v_exp_f32 v66, v66
    v_exp_f32 v67, v67
    v_exp_f32 v68, v68
    v_exp_f32 v69, v69
    v_exp_f32 v70, v70
    v_smfmac_f32_32x32x32_bf16 v[92:107], v[36:39], v[60:67], v8
    v_exp_f32 v71, v71
    v_exp_f32 v72, v72
    v_exp_f32 v73, v73
    v_exp_f32 v74, v74
    v_exp_f32 v75, v75
    v_exp_f32 v44, v44
    v_exp_f32 v45, v45
    v_smfmac_f32_32x32x32_bf16 v[92:107], v[40:43], v[68:75], v8
    v_exp_f32 v46, v46
    v_exp_f32 v47, v47
    v_exp_f32 v48, v48
    v_mfma_f32_32x32x16_bf16 v[60:75], v[20:23], v[16:19], 0
    v_exp_f32 v49, v49
    v_exp_f32 v50, v50
    v_exp_f32 v51, v51
    v_exp_f32 v52, v52
    v_exp_f32 v53, v53
    s_waitcnt lgkmcnt(1)
    v_exp_f32 v54, v54
    v_smfmac_f32_32x32x32_bf16 v[76:91], v[28:31], v[44:51], v8
    v_exp_f32 v55, v55
    v_exp_f32 v56, v56
    v_exp_f32 v57, v57
    v_exp_f32 v58, v58
    v_exp_f32 v59, v59
    v_exp_f32 v60, v60
    v_exp_f32 v61, v61
    v_smfmac_f32_32x32x32_bf16 v[76:91], v[32:35], v[52:59], v8
    s_mov_b64 exec, s[86:87]
    ds_read_b128 v[36:39], v10 offset:21504
    ds_read_b128 v[40:43], v10 offset:22016
    s_mov_b64 exec, -1
    v_exp_f32 v62, v62
    v_exp_f32 v63, v63
    v_exp_f32 v64, v64
    s_waitcnt lgkmcnt(2)
    v_mfma_f32_32x32x16_bf16 v[44:59], v[24:27], v[12:15], 0
    ds_read_b128 v[20:23], v9 offset:24576
    v_exp_f32 v65, v65
    v_exp_f32 v66, v66
    v_exp_f32 v67, v67
    v_exp_f32 v68, v68
    v_exp_f32 v69, v69
    v_exp_f32 v70, v70
    v_smfmac_f32_32x32x32_bf16 v[92:107], v[28:31], v[60:67], v8
    v_exp_f32 v71, v71
    v_exp_f32 v72, v72
    v_exp_f32 v73, v73
    v_exp_f32 v74, v74
    v_exp_f32 v75, v75
    v_exp_f32 v44, v44
    v_exp_f32 v45, v45
    v_smfmac_f32_32x32x32_bf16 v[92:107], v[32:35], v[68:75], v8
    v_exp_f32 v46, v46
    v_exp_f32 v47, v47
    v_exp_f32 v48, v48
    v_mfma_f32_32x32x16_bf16 v[60:75], v[24:27], v[16:19], 0
    v_exp_f32 v49, v49
    v_exp_f32 v50, v50
    v_exp_f32 v51, v51
    v_exp_f32 v52, v52
    v_exp_f32 v53, v53
    s_waitcnt lgkmcnt(1)
    v_exp_f32 v54, v54
    v_smfmac_f32_32x32x32_bf16 v[76:91], v[36:39], v[44:51], v8
    v_exp_f32 v55, v55
    v_exp_f32 v56, v56
    v_exp_f32 v57, v57
    v_exp_f32 v58, v58
    v_exp_f32 v59, v59
    v_exp_f32 v60, v60
    v_exp_f32 v61, v61
    v_smfmac_f32_32x32x32_bf16 v[76:91], v[40:43], v[52:59], v8
    s_mov_b64 exec, s[86:87]
    ds_read_b128 v[28:31], v10 offset:25600
    ds_read_b128 v[32:35], v10 offset:26112
    s_mov_b64 exec, -1
    v_exp_f32 v62, v62
    v_exp_f32 v63, v63
    v_exp_f32 v64, v64
    s_waitcnt lgkmcnt(2)
    v_mfma_f32_32x32x16_bf16 v[44:59], v[20:23], v[12:15], 0
    ds_read_b128 v[24:27], v9 offset:28672
    v_exp_f32 v65, v65
    v_exp_f32 v66, v66
    v_exp_f32 v67, v67
    v_exp_f32 v68, v68
    v_exp_f32 v69, v69
    v_exp_f32 v70, v70
    v_smfmac_f32_32x32x32_bf16 v[92:107], v[36:39], v[60:67], v8
    v_exp_f32 v71, v71
    v_exp_f32 v72, v72
    v_exp_f32 v73, v73
    v_exp_f32 v74, v74
    v_exp_f32 v75, v75
    v_exp_f32 v44, v44
    v_exp_f32 v45, v45
    v_smfmac_f32_32x32x32_bf16 v[92:107], v[40:43], v[68:75], v8
    v_exp_f32 v46, v46
    v_exp_f32 v47, v47
    v_exp_f32 v48, v48
    v_mfma_f32_32x32x16_bf16 v[60:75], v[20:23], v[16:19], 0
    v_exp_f32 v49, v49
    v_exp_f32 v50, v50
    v_exp_f32 v51, v51
    v_exp_f32 v52, v52
    v_exp_f32 v53, v53
    s_waitcnt lgkmcnt(1)
    v_exp_f32 v54, v54
    v_smfmac_f32_32x32x32_bf16 v[76:91], v[28:31], v[44:51], v8
    v_exp_f32 v55, v55
    v_exp_f32 v56, v56
    v_exp_f32 v57, v57
    v_exp_f32 v58, v58
    v_exp_f32 v59, v59
    v_exp_f32 v60, v60
    v_exp_f32 v61, v61
    v_smfmac_f32_32x32x32_bf16 v[76:91], v[32:35], v[52:59], v8
    s_mov_b64 exec, s[86:87]
    ds_read_b128 v[36:39], v10 offset:29696
    ds_read_b128 v[40:43], v10 offset:30208
    s_mov_b64 exec, -1
    v_exp_f32 v62, v62
    v_exp_f32 v63, v63
    v_exp_f32 v64, v64
    s_waitcnt lgkmcnt(2)
    v_mfma_f32_32x32x16_bf16 v[44:59], v[24:27], v[12:15], 0
    ds_read_b128 v[20:23], v9 offset:32768
    v_exp_f32 v65, v65
    v_exp_f32 v66, v66
    v_exp_f32 v67, v67
    v_exp_f32 v68, v68
    v_exp_f32 v69, v69
    v_exp_f32 v70, v70
    v_smfmac_f32_32x32x32_bf16 v[92:107], v[28:31], v[60:67], v8
    v_exp_f32 v71, v71
    v_exp_f32 v72, v72
    v_exp_f32 v73, v73
    v_exp_f32 v74, v74
    v_exp_f32 v75, v75
    v_exp_f32 v44, v44
    v_exp_f32 v45, v45
    v_smfmac_f32_32x32x32_bf16 v[92:107], v[32:35], v[68:75], v8
    v_exp_f32 v46, v46
    v_exp_f32 v47, v47
    v_exp_f32 v48, v48
    v_mfma_f32_32x32x16_bf16 v[60:75], v[24:27], v[16:19], 0
    v_exp_f32 v49, v49
    v_exp_f32 v50, v50
    v_exp_f32 v51, v51
    v_exp_f32 v52, v52
    v_exp_f32 v53, v53
    s_waitcnt lgkmcnt(1)
    v_exp_f32 v54, v54
    v_smfmac_f32_32x32x32_bf16 v[76:91], v[36:39], v[44:51], v8
    v_exp_f32 v55, v55
    v_exp_f32 v56, v56
    v_exp_f32 v57, v57
    v_exp_f32 v58, v58
    v_exp_f32 v59, v59
    v_exp_f32 v60, v60
    v_exp_f32 v61, v61
    v_smfmac_f32_32x32x32_bf16 v[76:91], v[40:43], v[52:59], v8
    s_mov_b64 exec, s[86:87]
    ds_read_b128 v[28:31], v10 offset:33792
    ds_read_b128 v[32:35], v10 offset:34304
    s_mov_b64 exec, -1
    v_exp_f32 v62, v62
    v_exp_f32 v63, v63
    v_exp_f32 v64, v64
    s_waitcnt lgkmcnt(2)
    v_mfma_f32_32x32x16_bf16 v[44:59], v[20:23], v[12:15], 0
    ds_read_b128 v[24:27], v9 offset:36864
    v_exp_f32 v65, v65
    v_exp_f32 v66, v66
    v_exp_f32 v67, v67
    v_exp_f32 v68, v68
    v_exp_f32 v69, v69
    v_exp_f32 v70, v70
    v_smfmac_f32_32x32x32_bf16 v[92:107], v[36:39], v[60:67], v8
    v_exp_f32 v71, v71
    v_exp_f32 v72, v72
    v_exp_f32 v73, v73
    v_exp_f32 v74, v74
    v_exp_f32 v75, v75
    v_exp_f32 v44, v44
    v_exp_f32 v45, v45
    v_smfmac_f32_32x32x32_bf16 v[92:107], v[40:43], v[68:75], v8
    v_exp_f32 v46, v46
    v_exp_f32 v47, v47
    v_exp_f32 v48, v48
    v_mfma_f32_32x32x16_bf16 v[60:75], v[20:23], v[16:19], 0
    v_exp_f32 v49, v49
    v_exp_f32 v50, v50
    v_exp_f32 v51, v51
    v_exp_f32 v52, v52
    v_exp_f32 v53, v53
    s_waitcnt lgkmcnt(1)
    v_exp_f32 v54, v54
    v_smfmac_f32_32x32x32_bf16 v[76:91], v[28:31], v[44:51], v8
    v_exp_f32 v55, v55
    v_exp_f32 v56, v56
    v_exp_f32 v57, v57
    v_exp_f32 v58, v58
    v_exp_f32 v59, v59
    v_exp_f32 v60, v60
    v_exp_f32 v61, v61
    v_smfmac_f32_32x32x32_bf16 v[76:91], v[32:35], v[52:59], v8
    s_mov_b64 exec, s[86:87]
    ds_read_b128 v[36:39], v10 offset:37888
    ds_read_b128 v[40:43], v10 offset:38400
    s_mov_b64 exec, -1
    v_exp_f32 v62, v62
    v_exp_f32 v63, v63
    v_exp_f32 v64, v64
    s_waitcnt lgkmcnt(2)
    v_mfma_f32_32x32x16_bf16 v[44:59], v[24:27], v[12:15], 0
    ds_read_b128 v[20:23], v9 offset:40960
    v_exp_f32 v65, v65
    v_exp_f32 v66, v66
    v_exp_f32 v67, v67
    v_exp_f32 v68, v68
    v_exp_f32 v69, v69
    v_exp_f32 v70, v70
    v_smfmac_f32_32x32x32_bf16 v[92:107], v[28:31], v[60:67], v8
    v_exp_f32 v71, v71
    v_exp_f32 v72, v72
    v_exp_f32 v73, v73
    v_exp_f32 v74, v74
    v_exp_f32 v75, v75
    v_exp_f32 v44, v44
    v_exp_f32 v45, v45
    v_smfmac_f32_32x32x32_bf16 v[92:107], v[32:35], v[68:75], v8
    v_exp_f32 v46, v46
    v_exp_f32 v47, v47
    v_exp_f32 v48, v48
    v_mfma_f32_32x32x16_bf16 v[60:75], v[24:27], v[16:19], 0
    v_exp_f32 v49, v49
    v_exp_f32 v50, v50
    v_exp_f32 v51, v51
    v_exp_f32 v52, v52
    v_exp_f32 v53, v53
    s_waitcnt lgkmcnt(1)
    v_exp_f32 v54, v54
    v_smfmac_f32_32x32x32_bf16 v[76:91], v[36:39], v[44:51], v8
    v_exp_f32 v55, v55
    v_exp_f32 v56, v56
    v_exp_f32 v57, v57
    v_exp_f32 v58, v58
    v_exp_f32 v59, v59
    v_exp_f32 v60, v60
    v_exp_f32 v61, v61
    v_smfmac_f32_32x32x32_bf16 v[76:91], v[40:43], v[52:59], v8
    s_mov_b64 exec, s[86:87]
    ds_read_b128 v[28:31], v10 offset:41984
    ds_read_b128 v[32:35], v10 offset:42496
    s_mov_b64 exec, -1
    v_exp_f32 v62, v62
    v_exp_f32 v63, v63
    v_exp_f32 v64, v64
    s_waitcnt lgkmcnt(2)
    v_mfma_f32_32x32x16_bf16 v[44:59], v[20:23], v[12:15], 0
    ds_read_b128 v[24:27], v9 offset:45056
    v_exp_f32 v65, v65
    v_exp_f32 v66, v66
    v_exp_f32 v67, v67
    v_exp_f32 v68, v68
    v_exp_f32 v69, v69
    v_exp_f32 v70, v70
    v_smfmac_f32_32x32x32_bf16 v[92:107], v[36:39], v[60:67], v8
    v_exp_f32 v71, v71
    v_exp_f32 v72, v72
    v_exp_f32 v73, v73
    v_exp_f32 v74, v74
    v_exp_f32 v75, v75
    v_exp_f32 v44, v44
    v_exp_f32 v45, v45
    v_smfmac_f32_32x32x32_bf16 v[92:107], v[40:43], v[68:75], v8
    v_exp_f32 v46, v46
    v_exp_f32 v47, v47
    v_exp_f32 v48, v48
    v_mfma_f32_32x32x16_bf16 v[60:75], v[20:23], v[16:19], 0
    v_exp_f32 v49, v49
    v_exp_f32 v50, v50
    v_exp_f32 v51, v51
    v_exp_f32 v52, v52
    v_exp_f32 v53, v53
    s_waitcnt lgkmcnt(1)
    v_exp_f32 v54, v54
    v_smfmac_f32_32x32x32_bf16 v[76:91], v[28:31], v[44:51], v8
    v_exp_f32 v55, v55
    v_exp_f32 v56, v56
    v_exp_f32 v57, v57
    v_exp_f32 v58, v58
    v_exp_f32 v59, v59
    v_exp_f32 v60, v60
    v_exp_f32 v61, v61
    v_smfmac_f32_32x32x32_bf16 v[76:91], v[32:35], v[52:59], v8
    s_mov_b64 exec, s[86:87]
    ds_read_b128 v[36:39], v10 offset:46080
    ds_read_b128 v[40:43], v10 offset:46592
    s_mov_b64 exec, -1
    v_exp_f32 v62, v62
    v_exp_f32 v63, v63
    v_exp_f32 v64, v64
    s_waitcnt lgkmcnt(2)
    v_mfma_f32_32x32x16_bf16 v[44:59], v[24:27], v[12:15], 0
    ds_read_b128 v[20:23], v9 offset:49152
    v_exp_f32 v65, v65
    v_exp_f32 v66, v66
    v_exp_f32 v67, v67
    v_exp_f32 v68, v68
    v_exp_f32 v69, v69
    v_exp_f32 v70, v70
    v_smfmac_f32_32x32x32_bf16 v[92:107], v[28:31], v[60:67], v8
    v_exp_f32 v71, v71
    v_exp_f32 v72, v72
    v_exp_f32 v73, v73
    v_exp_f32 v74, v74
    v_exp_f32 v75, v75
    v_exp_f32 v44, v44
    v_exp_f32 v45, v45
    v_smfmac_f32_32x32x32_bf16 v[92:107], v[32:35], v[68:75], v8
    v_exp_f32 v46, v46
    v_exp_f32 v47, v47
    v_exp_f32 v48, v48
    v_mfma_f32_32x32x16_bf16 v[60:75], v[24:27], v[16:19], 0
    v_exp_f32 v49, v49
    v_exp_f32 v50, v50
    v_exp_f32 v51, v51
    v_exp_f32 v52, v52
    v_exp_f32 v53, v53
    s_waitcnt lgkmcnt(1)
    v_exp_f32 v54, v54
    v_smfmac_f32_32x32x32_bf16 v[76:91], v[36:39], v[44:51], v8
    v_exp_f32 v55, v55
    v_exp_f32 v56, v56
    v_exp_f32 v57, v57
    v_exp_f32 v58, v58
    v_exp_f32 v59, v59
    v_exp_f32 v60, v60
    v_exp_f32 v61, v61
    v_smfmac_f32_32x32x32_bf16 v[76:91], v[40:43], v[52:59], v8
    s_mov_b64 exec, s[86:87]
    ds_read_b128 v[28:31], v10 offset:50176
    ds_read_b128 v[32:35], v10 offset:50688
    s_mov_b64 exec, -1
    v_exp_f32 v62, v62
    v_exp_f32 v63, v63
    v_exp_f32 v64, v64
    s_waitcnt lgkmcnt(2)
    v_mfma_f32_32x32x16_bf16 v[44:59], v[20:23], v[12:15], 0
    ds_read_b128 v[24:27], v9 offset:53248
    v_exp_f32 v65, v65
    v_exp_f32 v66, v66
    v_exp_f32 v67, v67
    v_exp_f32 v68, v68
    v_exp_f32 v69, v69
    v_exp_f32 v70, v70
    v_smfmac_f32_32x32x32_bf16 v[92:107], v[36:39], v[60:67], v8
    v_exp_f32 v71, v71
    v_exp_f32 v72, v72
    v_exp_f32 v73, v73
    v_exp_f32 v74, v74
    v_exp_f32 v75, v75
    s_waitcnt lgkmcnt(0)
    s_mov_b32 s84, 400000
spin_85:
    ds_read_b32 v2, v1 offset:32024
    s_waitcnt lgkmcnt(0)
    v_readfirstlane_b32 s72, v2
    s_cmp_eq_u32 s72, 0x8
    s_cbranch_scc1 spind_86
    s_sub_u32 s84, s84, 1
    s_cbranch_scc1 spind_86
    s_sleep 1
    s_branch spin_85
spind_86:
    v_exp_f32 v44, v44
    v_exp_f32 v45, v45
    v_smfmac_f32_32x32x32_bf16 v[92:107], v[40:43], v[68:75], v8
    v_exp_f32 v46, v46
    v_exp_f32 v47, v47
    v_exp_f32 v48, v48
    v_mfma_f32_32x32x16_bf16 v[60:75], v[20:23], v[16:19], 0
    v_exp_f32 v49, v49
    v_exp_f32 v50, v50
    v_exp_f32 v51, v51
    v_exp_f32 v52, v52
    v_exp_f32 v53, v53
    s_waitcnt lgkmcnt(1)
    v_exp_f32 v54, v54
    v_smfmac_f32_32x32x32_bf16 v[76:91], v[28:31], v[44:51], v8
    v_exp_f32 v55, v55
    v_exp_f32 v56, v56
    v_exp_f32 v57, v57
    v_exp_f32 v58, v58
    v_exp_f32 v59, v59
    v_exp_f32 v60, v60
    v_exp_f32 v61, v61
    v_smfmac_f32_32x32x32_bf16 v[76:91], v[32:35], v[52:59], v8
    s_mov_b64 exec, s[86:87]
    ds_read_b128 v[36:39], v10 offset:54272
    ds_read_b128 v[40:43], v10 offset:54784
    s_mov_b64 exec, -1
    v_exp_f32 v62, v62
    v_exp_f32 v63, v63
    v_exp_f32 v64, v64
    s_waitcnt lgkmcnt(2)
    v_mfma_f32_32x32x16_bf16 v[44:59], v[24:27], v[12:15], 0
    ds_read_b128 v[20:23], v9 offset:57344
    v_exp_f32 v65, v65
    v_exp_f32 v66, v66
    v_exp_f32 v67, v67
    v_exp_f32 v68, v68
    v_exp_f32 v69, v69
    v_exp_f32 v70, v70
    v_smfmac_f32_32x32x32_bf16 v[92:107], v[28:31], v[60:67], v8
    v_exp_f32 v71, v71
    v_exp_f32 v72, v72
    v_exp_f32 v73, v73
    v_exp_f32 v74, v74
    v_exp_f32 v75, v75
    s_setprio 0
    v_exp_f32 v44, v44
    v_exp_f32 v45, v45
    v_smfmac_f32_32x32x32_bf16 v[92:107], v[32:35], v[68:75], v8
    v_exp_f32 v46, v46
    v_exp_f32 v47, v47
    v_exp_f32 v48, v48
    v_mfma_f32_32x32x16_bf16 v[60:75], v[24:27], v[16:19], 0
    v_exp_f32 v49, v49
    v_exp_f32 v50, v50
    v_exp_f32 v51, v51
    v_exp_f32 v52, v52
    v_exp_f32 v53, v53
    s_waitcnt lgkmcnt(1)
    v_exp_f32 v54, v54
    v_smfmac_f32_32x32x32_bf16 v[76:91], v[36:39], v[44:51], v8
    v_exp_f32 v55, v55
    v_exp_f32 v56, v56
    v_exp_f32 v57, v57
    v_exp_f32 v58, v58
    v_exp_f32 v59, v59
    v_exp_f32 v60, v60
    v_exp_f32 v61, v61
    v_smfmac_f32_32x32x32_bf16 v[76:91], v[40:43], v[52:59], v8
    s_mov_b64 exec, s[86:87]
    ds_read_b128 v[28:31], v10 offset:58368
    ds_read_b128 v[32:35], v10 offset:58880
    s_mov_b64 exec, -1
    v_exp_f32 v62, v62
    v_exp_f32 v63, v63
    v_exp_f32 v64, v64
    s_waitcnt lgkmcnt(2)
    v_mfma_f32_32x32x16_bf16 v[44:59], v[20:23], v[12:15], 0
    ds_read_b128 v[24:27], v9 offset:61440
    v_exp_f32 v65, v65
    v_exp_f32 v66, v66
    v_exp_f32 v67, v67
    v_exp_f32 v68, v68
    v_exp_f32 v69, v69
    v_exp_f32 v70, v70
    v_smfmac_f32_32x32x32_bf16 v[92:107], v[36:39], v[60:67], v8
    v_exp_f32 v71, v71
    v_exp_f32 v72, v72
    v_exp_f32 v73, v73
    v_exp_f32 v74, v74
    v_exp_f32 v75, v75
    v_exp_f32 v44, v44
    v_exp_f32 v45, v45
    v_smfmac_f32_32x32x32_bf16 v[92:107], v[40:43], v[68:75], v8
    v_exp_f32 v46, v46
    v_exp_f32 v47, v47
    v_exp_f32 v48, v48
    v_mfma_f32_32x32x16_bf16 v[60:75], v[20:23], v[16:19], 0
    v_exp_f32 v49, v49
    v_exp_f32 v50, v50
    v_exp_f32 v51, v51
    v_exp_f32 v52, v52
    v_exp_f32 v53, v53
    s_waitcnt lgkmcnt(1)
    v_exp_f32 v54, v54
    v_smfmac_f32_32x32x32_bf16 v[76:91], v[28:31], v[44:51], v8
    v_exp_f32 v55, v55
    v_exp_f32 v56, v56
    v_exp_f32 v57, v57
    v_exp_f32 v58, v58
    v_exp_f32 v59, v59
    v_exp_f32 v60, v60
    v_exp_f32 v61, v61
    v_smfmac_f32_32x32x32_bf16 v[76:91], v[32:35], v[52:59], v8
    s_mov_b64 exec, s[86:87]
    ds_read_b128 v[36:39], v10 offset:62464
    ds_read_b128 v[40:43], v10 offset:62976
    s_mov_b64 exec, -1
    v_exp_f32 v62, v62
    v_exp_f32 v63, v63
    v_exp_f32 v64, v64
    s_waitcnt lgkmcnt(2)
    v_mfma_f32_32x32x16_bf16 v[44:59], v[24:27], v[12:15], 0
    v_exp_f32 v65, v65
    v_exp_f32 v66, v66
    v_exp_f32 v67, v67
    v_exp_f32 v68, v68
    v_exp_f32 v69, v69
    v_exp_f32 v70, v70
    v_smfmac_f32_32x32x32_bf16 v[92:107], v[28:31], v[60:67], v8
    v_exp_f32 v71, v71
    v_exp_f32 v72, v72
    v_exp_f32 v73, v73
    v_exp_f32 v74, v74
    v_exp_f32 v75, v75
    ds_read_b32 v127, v124 offset:16
    ds_read_b32 v125, v1 offset:32044
    ds_read_b128 v[128:131], v122 offset:0
    ds_read_b128 v[132:135], v122 offset:1024
    ds_read_b32 v136, v123 offset:2048
    ds_read_b128 v[140:143], v122 offset:2304
    ds_read_b128 v[144:147], v122 offset:3328
    ds_read_b32 v148, v123 offset:4352
    v_exp_f32 v44, v44
    v_exp_f32 v45, v45
    v_smfmac_f32_32x32x32_bf16 v[92:107], v[32:35], v[68:75], v8
    v_exp_f32 v46, v46
    v_exp_f32 v47, v47
    v_exp_f32 v48, v48
    v_mfma_f32_32x32x16_bf16 v[60:75], v[24:27], v[16:19], 0
    v_exp_f32 v49, v49
    v_exp_f32 v50, v50
    v_exp_f32 v51, v51
    v_exp_f32 v52, v52
    v_exp_f32 v53, v53
    s_waitcnt lgkmcnt(0)
    v_exp_f32 v54, v54
    v_smfmac_f32_32x32x32_bf16 v[76:91], v[36:39], v[44:51], v8
    v_exp_f32 v55, v55
    v_exp_f32 v56, v56
    v_exp_f32 v57, v57
    v_exp_f32 v58, v58
    v_exp_f32 v59, v59
    v_exp_f32 v60, v60
    v_exp_f32 v61, v61
    v_smfmac_f32_32x32x32_bf16 v[76:91], v[40:43], v[52:59], v8
    v_exp_f32 v62, v62
    v_exp_f32 v63, v63
    v_exp_f32 v64, v64
    v_exp_f32 v65, v65
    v_exp_f32 v66, v66
    v_exp_f32 v67, v67
    v_exp_f32 v68, v68
    v_exp_f32 v69, v69
    v_exp_f32 v70, v70
    v_smfmac_f32_32x32x32_bf16 v[92:107], v[36:39], v[60:67], v8
    v_exp_f32 v71, v71
    v_exp_f32 v72, v72
    v_exp_f32 v73, v73
    v_exp_f32 v74, v74
    v_exp_f32 v75, v75
    s_nop 1
    v_smfmac_f32_32x32x32_bf16 v[92:107], v[40:43], v[68:75], v8
    v_readfirstlane_b32 s73, v127
    v_readfirstlane_b32 s81, v125
    s_cmp_eq_u32 s73, 1
    s_cbranch_scc1 L_A_LATE
    v_mov_b32 v2, 1
    s_mov_b64 exec, 1
    ds_add_rtn_u32 v3, v124, v2
    s_mov_b64 exec, -1
    s_waitcnt lgkmcnt(0)
    v_readfirstlane_b32 s73, v3
    s_cmp_eq_u32 s73, 0
    s_cbranch_scc0 L_A_TIE
    s_nop 3
    ds_write_b128 v122, v[76:79] offset:0
    ds_write_b128 v122, v[80:83] offset:1024
    ds_write_b32 v123, v84 offset:2048
    ds_write_b128 v122, v[92:95] offset:2304
    ds_write_b128 v122, v[96:99] offset:3328
    ds_write_b32 v123, v100 offset:4352
    s_mov_b64 exec, 1
    ds_write_b32 v124, v2 offset:16
    s_mov_b64 exec, -1
    s_waitcnt lgkmcnt(0)
    s_branch L_A_STD
L_A_TIE:
    s_mov_b32 s84, 400000
L_A_TI2:
    ds_read_b32 v127, v124 offset:16
    ds_read_b128 v[128:131], v122 offset:0
    ds_read_b128 v[132:135], v122 offset:1024
    ds_read_b32 v136, v123 offset:2048
    ds_read_b128 v[140:143], v122 offset:2304
    ds_read_b128 v[144:147], v122 offset:3328
    ds_read_b32 v148, v123 offset:4352
    s_waitcnt lgkmcnt(0)
    v_readfirstlane_b32 s73, v127
    s_cmp_eq_u32 s73, 1
    s_cbranch_scc1 L_A_LATE
    s_sub_u32 s84, s84, 1
    s_cbranch_scc0 L_A_TI2
L_A_LATE:
    v_add_f32 v76, v76, v140
    v_add_f32 v77, v77, v141
    v_add_f32 v78, v78, v142
    v_add_f32 v79, v79, v143
    v_add_f32 v80, v80, v144
    v_add_f32 v81, v81, v145
    v_add_f32 v82, v82, v146
    v_add_f32 v83, v83, v147
    v_add_f32 v84, v84, v148
    v_add_f32 v92, v92, v128
    v_add_f32 v93, v93, v129
    v_add_f32 v94, v94, v130
    v_add_f32 v95, v95, v131
    v_add_f32 v96, v96, v132
    v_add_f32 v97, v97, v133
    v_add_f32 v98, v98, v134
    v_add_f32 v99, v99, v135
    v_add_f32 v100, v100, v136
    v_add_f32 v2, |v76|, |v77|
    v_add_f32 v4, |v92|, |v93|
    v_add_f32 v2, v2, |v78|
    v_add_f32 v4, v4, |v94|
    v_add_f32 v2, v2, |v79|
    v_add_f32 v4, v4, |v95|
    v_add_f32 v2, v2, |v80|
    v_add_f32 v4, v4, |v96|
    v_add_f32 v2, v2, |v81|
    v_add_f32 v4, v4, |v97|
    v_add_f32 v2, v2, |v82|
    v_add_f32 v4, v4, |v98|
    v_add_f32 v2, v2, |v83|
    v_add_f32 v4, v4, |v99|
    s_mov_b32 s74, 0x7f800000
    s_mov_b32 s75, 0x33800000
    s_mov_b32 s76, 0x5d800000
    v_cmp_ngt_f32 s[72:73], s74, v2
    v_cmp_ngt_f32 s[82:83], s74, v4
    v_cmp_nle_f32 vcc, s75, v84
    v_cmp_nle_f32 s[78:79], s75, v100
    s_or_b64 s[72:73], s[72:73], vcc
    s_or_b64 s[82:83], s[82:83], s[78:79]
    v_cmp_nge_f32 vcc, s76, v84
    v_cmp_nge_f32 s[78:79], s76, v100
    s_or_b64 s[72:73], s[72:73], vcc
    s_or_b64 s[82:83], s[82:83], s[78:79]
    s_or_b64 vcc, s[72:73], s[82:83]
    s_cbranch_scc1 L_FB_AX
L_FB_AX_BACK:
    v_rcp_f32 v2, v84
    v_rcp_f32 v4, v100
    s_xor_b32 s73, s80, 0x400
    s_waitcnt vmcnt(0)
    v_mul_f32 v2, v2, v126
    v_mul_f32 v4, v4, v126
    v_pk_mul_f32 v[76:77], v[76:77], v[2:3] op_sel_hi:[1,0]
    v_pk_mul_f32 v[92:93], v[92:93], v[4:5] op_sel_hi:[1,0]
    v_pk_mul_f32 v[78:79], v[78:79], v[2:3] op_sel_hi:[1,0]
    v_pk_mul_f32 v[94:95], v[94:95], v[4:5] op_sel_hi:[1,0]
    v_pk_mul_f32 v[80:81], v[80:81], v[2:3] op_sel_hi:[1,0]
    v_pk_mul_f32 v[96:97], v[96:97], v[4:5] op_sel_hi:[1,0]
    v_pk_mul_f32 v[82:83], v[82:83], v[2:3] op_sel_hi:[1,0]
    v_pk_mul_f32 v[98:99], v[98:99], v[4:5] op_sel_hi:[1,0]
    v_cvt_pk_bf16_f32 v152, v76, v77
    v_cvt_pk_bf16_f32 v156, v92, v93
    v_cvt_pk_bf16_f32 v153, v78, v79
    v_cvt_pk_bf16_f32 v157, v94, v95
    v_cvt_pk_bf16_f32 v154, v80, v81
    v_cvt_pk_bf16_f32 v158, v96, v97
    v_cvt_pk_bf16_f32 v155, v82, v83
    v_cvt_pk_bf16_f32 v159, v98, v99
    v_min_u32 v152, -2, v152
    v_min_u32 v156, -2, v156
    s_cmp_eq_u32 s81, 0
    s_cbranch_scc1 L_A_FAR
    buffer_store_dwordx4 v[152:155], v6, s[60:63], s80 offen nt
    buffer_store_dwordx4 v[156:159], v6, s[60:63], s73 offen nt
    s_branch L_A_STD
L_A_FAR:
    buffer_store_dwordx4 v[152:155], v6, s[60:63], s80 offen sc1
    buffer_store_dwordx4 v[156:159], v6, s[60:63], s73 offen sc1
L_A_STD:
L_END:
    s_endpgm
L_CODE_END:
L_FB_B0:
    s_add_i32 s74, s81, 0
    s_cmp_ge_i32 s74, 0
    s_cselect_b32 s76, 1, 0
    s_max_i32 s74, s74, 0
    s_add_i32 s75, s81, 9
    s_sub_u32 s75, s75, s74
    s_add_u32 s74, s74, s80
    s_lshl_b32 s74, s74, 11
    s_add_u32 s74, s74, 0x240000
    v_mov_b32 v3, 0xff800000
    s_mov_b32 s77, s74
    s_mov_b32 s78, 0
fbl_19:
    buffer_load_dwordx4 v[24:27], v160, s[60:63], s77 offen sc1
    s_waitcnt vmcnt(0)
    s_add_u32 s79, s78, 1
    s_cmp_eq_u32 s79, s75
    s_cbranch_scc1 fbm_20
    s_cmp_lt_u32 s78, s76
    s_cbranch_scc1 fbm_21
    v_mfma_f32_32x32x16_bf16 v[64:79], v[24:27], v[16:19], 0
    s_branch fbm_22
fbm_20:
    v_mfma_f32_32x32x16_bf16 v[64:79], v[24:27], v[16:19], v[144:159]
    s_branch fbm_22
fbm_21:
    v_mfma_f32_32x32x16_bf16 v[64:79], v[24:27], v[16:19], v[128:143]
fbm_22:
    s_nop 15
    v_max3_f32 v3, v64, v65, v3
    v_max3_f32 v3, v66, v67, v3
    v_max3_f32 v3, v68, v69, v3
    v_max3_f32 v3, v70, v71, v3
    v_max3_f32 v3, v72, v73, v3
    v_max3_f32 v3, v74, v75, v3
    v_max3_f32 v3, v76, v77, v3
    v_max3_f32 v3, v78, v79, v3
    s_add_u32 s77, s77, 2048
    s_add_u32 s78, s78, 1
    s_cmp_lt_u32 s78, s75
    s_cbranch_scc1 fbl_19
    v_mov_b32 v64, v3
    s_nop 1
    v_permlane32_swap_b32 v64, v3
    s_nop 1
    v_max_f32 v3, v3, v64
    v_mov_b32 v96, 0
    v_mov_b32 v97, 0
    v_mov_b32 v98, 0
    v_mov_b32 v99, 0
    v_mov_b32 v100, 0
    v_mov_b32 v101, 0
    v_mov_b32 v102, 0
    v_mov_b32 v103, 0
    v_mov_b32 v104, 0
    v_mov_b32 v105, 0
    v_mov_b32 v106, 0
    v_mov_b32 v107, 0
    v_mov_b32 v108, 0
    v_mov_b32 v109, 0
    v_mov_b32 v110, 0
    v_mov_b32 v111, 0
    s_mov_b32 s77, s74
    s_mov_b32 s78, 0
fbl_23:
    buffer_load_dwordx4 v[24:27], v160, s[60:63], s77 offen sc1
    s_mov_b64 exec, s[86:87]
    buffer_load_dwordx4 v[36:39], v161, s[60:63], s77 offen offset:1024 sc1
    buffer_load_dwordx4 v[40:43], v161, s[60:63], s77 offen offset:1536 sc1
    s_mov_b64 exec, -1
    s_waitcnt vmcnt(0)
    s_add_u32 s79, s78, 1
    s_cmp_eq_u32 s79, s75
    s_cbranch_scc1 fbm_24
    s_cmp_lt_u32 s78, s76
    s_cbranch_scc1 fbm_25
    v_mfma_f32_32x32x16_bf16 v[64:79], v[24:27], v[16:19], 0
    s_branch fbm_26
fbm_24:
    v_mfma_f32_32x32x16_bf16 v[64:79], v[24:27], v[16:19], v[144:159]
    s_branch fbm_26
fbm_25:
    v_mfma_f32_32x32x16_bf16 v[64:79], v[24:27], v[16:19], v[128:143]
fbm_26:
    s_nop 15
    v_sub_f32 v64, v64, v3
    v_sub_f32 v65, v65, v3
    v_sub_f32 v66, v66, v3
    v_sub_f32 v67, v67, v3
    v_sub_f32 v68, v68, v3
    v_sub_f32 v69, v69, v3
    v_sub_f32 v70, v70, v3
    v_sub_f32 v71, v71, v3
    v_sub_f32 v72, v72, v3
    v_sub_f32 v73, v73, v3
    v_sub_f32 v74, v74, v3
    v_sub_f32 v75, v75, v3
    v_sub_f32 v76, v76, v3
    v_sub_f32 v77, v77, v3
    v_sub_f32 v78, v78, v3
    v_sub_f32 v79, v79, v3
    v_exp_f32 v64, v64
    v_exp_f32 v65, v65
    v_exp_f32 v66, v66
    v_exp_f32 v67, v67
    v_exp_f32 v68, v68
    v_exp_f32 v69, v69
    v_exp_f32 v70, v70
    v_exp_f32 v71, v71
    v_exp_f32 v72, v72
    v_exp_f32 v73, v73
    v_exp_f32 v74, v74
    v_exp_f32 v75, v75
    v_exp_f32 v76, v76
    v_exp_f32 v77, v77
    v_exp_f32 v78, v78
    v_exp_f32 v79, v79
    s_nop 1
    v_smfmac_f32_32x32x32_bf16 v[96:111], v[36:39], v[64:71], v60
    v_smfmac_f32_32x32x32_bf16 v[96:111], v[40:43], v[72:79], v60
    s_add_u32 s77, s77, 2048
    s_add_u32 s78, s78, 1
    s_cmp_lt_u32 s78, s75
    s_cbranch_scc1 fbl_23
    s_nop 15
    s_branch L_FB_B0_BACK
L_FB_B1:
    s_add_i32 s74, s81, 1
    s_cmp_ge_i32 s74, 0
    s_cselect_b32 s76, 1, 0
    s_max_i32 s74, s74, 0
    s_add_i32 s75, s81, 10
    s_sub_u32 s75, s75, s74
    s_add_u32 s74, s74, s80
    s_lshl_b32 s74, s74, 11
    s_add_u32 s74, s74, 0x240000
    v_mov_b32 v3, 0xff800000
    s_mov_b32 s77, s74
    s_mov_b32 s78, 0
fbl_27:
    buffer_load_dwordx4 v[24:27], v160, s[60:63], s77 offen sc1
    s_waitcnt vmcnt(0)
    s_add_u32 s79, s78, 1
    s_cmp_eq_u32 s79, s75
    s_cbranch_scc1 fbm_28
    s_cmp_lt_u32 s78, s76
    s_cbranch_scc1 fbm_29
    v_mfma_f32_32x32x16_bf16 v[64:79], v[24:27], v[20:23], 0
    s_branch fbm_30
fbm_28:
    v_mfma_f32_32x32x16_bf16 v[64:79], v[24:27], v[20:23], v[144:159]
    s_branch fbm_30
fbm_29:
    v_mfma_f32_32x32x16_bf16 v[64:79], v[24:27], v[20:23], v[128:143]
fbm_30:
    s_nop 15
    v_max3_f32 v3, v64, v65, v3
    v_max3_f32 v3, v66, v67, v3
    v_max3_f32 v3, v68, v69, v3
    v_max3_f32 v3, v70, v71, v3
    v_max3_f32 v3, v72, v73, v3
    v_max3_f32 v3, v74, v75, v3
    v_max3_f32 v3, v76, v77, v3
    v_max3_f32 v3, v78, v79, v3
    s_add_u32 s77, s77, 2048
    s_add_u32 s78, s78, 1
    s_cmp_lt_u32 s78, s75
    s_cbranch_scc1 fbl_27
    v_mov_b32 v64, v3
    s_nop 1
    v_permlane32_swap_b32 v64, v3
    s_nop 1
    v_max_f32 v3, v3, v64
    v_mov_b32 v112, 0
    v_mov_b32 v113, 0
    v_mov_b32 v114, 0
    v_mov_b32 v115, 0
    v_mov_b32 v116, 0
    v_mov_b32 v117, 0
    v_mov_b32 v118, 0
    v_mov_b32 v119, 0
    v_mov_b32 v120, 0
    v_mov_b32 v121, 0
    v_mov_b32 v122, 0
    v_mov_b32 v123, 0
    v_mov_b32 v124, 0
    v_mov_b32 v125, 0
    v_mov_b32 v126, 0
    v_mov_b32 v127, 0
    s_mov_b32 s77, s74
    s_mov_b32 s78, 0
fbl_31:
    buffer_load_dwordx4 v[24:27], v160, s[60:63], s77 offen sc1
    s_mov_b64 exec, s[86:87]
    buffer_load_dwordx4 v[36:39], v161, s[60:63], s77 offen offset:1024 sc1
    buffer_load_dwordx4 v[40:43], v161, s[60:63], s77 offen offset:1536 sc1
    s_mov_b64 exec, -1
    s_waitcnt vmcnt(0)
    s_add_u32 s79, s78, 1
    s_cmp_eq_u32 s79, s75
    s_cbranch_scc1 fbm_32
    s_cmp_lt_u32 s78, s76
    s_cbranch_scc1 fbm_33
    v_mfma_f32_32x32x16_bf16 v[64:79], v[24:27], v[20:23], 0
    s_branch fbm_34
fbm_32:
    v_mfma_f32_32x32x16_bf16 v[64:79], v[24:27], v[20:23], v[144:159]
    s_branch fbm_34
fbm_33:
    v_mfma_f32_32x32x16_bf16 v[64:79], v[24:27], v[20:23], v[128:143]
fbm_34:
    s_nop 15
    v_sub_f32 v64, v64, v3
    v_sub_f32 v65, v65, v3
    v_sub_f32 v66, v66, v3
    v_sub_f32 v67, v67, v3
    v_sub_f32 v68, v68, v3
    v_sub_f32 v69, v69, v3
    v_sub_f32 v70, v70, v3
    v_sub_f32 v71, v71, v3
    v_sub_f32 v72, v72, v3
    v_sub_f32 v73, v73, v3
    v_sub_f32 v74, v74, v3
    v_sub_f32 v75, v75, v3
    v_sub_f32 v76, v76, v3
    v_sub_f32 v77, v77, v3
    v_sub_f32 v78, v78, v3
    v_sub_f32 v79, v79, v3
    v_exp_f32 v64, v64
    v_exp_f32 v65, v65
    v_exp_f32 v66, v66
    v_exp_f32 v67, v67
    v_exp_f32 v68, v68
    v_exp_f32 v69, v69
    v_exp_f32 v70, v70
    v_exp_f32 v71, v71
    v_exp_f32 v72, v72
    v_exp_f32 v73, v73
    v_exp_f32 v74, v74
    v_exp_f32 v75, v75
    v_exp_f32 v76, v76
    v_exp_f32 v77, v77
    v_exp_f32 v78, v78
    v_exp_f32 v79, v79
    s_nop 1
    v_smfmac_f32_32x32x32_bf16 v[112:127], v[36:39], v[64:71], v60
    v_smfmac_f32_32x32x32_bf16 v[112:127], v[40:43], v[72:79], v60
    s_add_u32 s77, s77, 2048
    s_add_u32 s78, s78, 1
    s_cmp_lt_u32 s78, s75
    s_cbranch_scc1 fbl_31
    s_nop 15
    s_branch L_FB_B1_BACK
L_FB_AX:
    s_cmp_lg_u64 s[72:73], 0
    s_cbranch_scc1 L_FB_A0
L_FB_AX2:
    s_cmp_lg_u64 s[82:83], 0
    s_cbranch_scc1 L_FB_A1
    s_branch L_FB_AX_BACK
L_FB_A0:
    s_mov_b32 s74, 0x20000
    s_mov_b32 s75, 64
    v_mov_b32 v3, 0xff800000
    s_mov_b32 s77, s74
    s_mov_b32 s78, 0
fbl_87:
    buffer_load_dwordx4 v[20:23], v6, s[60:63], s77 offen sc1
    s_waitcnt vmcnt(0)
    v_mfma_f32_32x32x16_bf16 v[44:59], v[20:23], v[12:15], 0
    s_nop 15
    v_max3_f32 v3, v44, v45, v3
    v_max3_f32 v3, v46, v47, v3
    v_max3_f32 v3, v48, v49, v3
    v_max3_f32 v3, v50, v51, v3
    v_max3_f32 v3, v52, v53, v3
    v_max3_f32 v3, v54, v55, v3
    v_max3_f32 v3, v56, v57, v3
    v_max3_f32 v3, v58, v59, v3
    s_add_u32 s77, s77, 2048
    s_add_u32 s78, s78, 1
    s_cmp_lt_u32 s78, s75
    s_cbranch_scc1 fbl_87
    v_mov_b32 v44, v3
    s_nop 1
    v_permlane32_swap_b32 v44, v3
    s_nop 1
    v_max_f32 v3, v3, v44
    v_mov_b32 v76, 0
    v_mov_b32 v77, 0
    v_mov_b32 v78, 0
    v_mov_b32 v79, 0
    v_mov_b32 v80, 0
    v_mov_b32 v81, 0
    v_mov_b32 v82, 0
    v_mov_b32 v83, 0
    v_mov_b32 v84, 0
    v_mov_b32 v85, 0
    v_mov_b32 v86, 0
    v_mov_b32 v87, 0
    v_mov_b32 v88, 0
    v_mov_b32 v89, 0
    v_mov_b32 v90, 0
    v_mov_b32 v91, 0
    s_mov_b32 s77, s74
    s_mov_b32 s78, 0
fbl_88:
    buffer_load_dwordx4 v[20:23], v6, s[60:63], s77 offen sc1
    s_mov_b64 exec, s[86:87]
    buffer_load_dwordx4 v[28:31], v7, s[60:63], s77 offen offset:1024 sc1
    buffer_load_dwordx4 v[32:35], v7, s[60:63], s77 offen offset:1536 sc1
    s_mov_b64 exec, -1
    s_waitcnt vmcnt(0)
    v_mfma_f32_32x32x16_bf16 v[44:59], v[20:23], v[12:15], 0
    s_nop 15
    v_sub_f32 v44, v44, v3
    v_sub_f32 v45, v45, v3
    v_sub_f32 v46, v46, v3
    v_sub_f32 v47, v47, v3
    v_sub_f32 v48, v48, v3
    v_sub_f32 v49, v49, v3
    v_sub_f32 v50, v50, v3
    v_sub_f32 v51, v51, v3
    v_sub_f32 v52, v52, v3
    v_sub_f32 v53, v53, v3
    v_sub_f32 v54, v54, v3
    v_sub_f32 v55, v55, v3
    v_sub_f32 v56, v56, v3
    v_sub_f32 v57, v57, v3
    v_sub_f32 v58, v58, v3
    v_sub_f32 v59, v59, v3
    v_exp_f32 v44, v44
    v_exp_f32 v45, v45
    v_exp_f32 v46, v46
    v_exp_f32 v47, v47
    v_exp_f32 v48, v48
    v_exp_f32 v49, v49
    v_exp_f32 v50, v50
    v_exp_f32 v51, v51
    v_exp_f32 v52, v52
    v_exp_f32 v53, v53
    v_exp_f32 v54, v54
    v_exp_f32 v55, v55
    v_exp_f32 v56, v56
    v_exp_f32 v57, v57
    v_exp_f32 v58, v58
    v_exp_f32 v59, v59
    s_nop 1
    v_smfmac_f32_32x32x32_bf16 v[76:91], v[28:31], v[44:51], v8
    v_smfmac_f32_32x32x32_bf16 v[76:91], v[32:35], v[52:59], v8
    s_add_u32 s77, s77, 2048
    s_add_u32 s78, s78, 1
    s_cmp_lt_u32 s78, s75
    s_cbranch_scc1 fbl_88
    s_nop 15
    s_branch L_FB_AX2
L_FB_A1:
    s_mov_b32 s74, 0x20000
    s_mov_b32 s75, 64
    v_mov_b32 v3, 0xff800000
    s_mov_b32 s77, s74
    s_mov_b32 s78, 0
fbl_89:
    buffer_load_dwordx4 v[20:23], v6, s[60:63], s77 offen sc1
    s_waitcnt vmcnt(0)
    v_mfma_f32_32x32x16_bf16 v[44:59], v[20:23], v[16:19], 0
    s_nop 15
    v_max3_f32 v3, v44, v45, v3
    v_max3_f32 v3, v46, v47, v3
    v_max3_f32 v3, v48, v49, v3
    v_max3_f32 v3, v50, v51, v3
    v_max3_f32 v3, v52, v53, v3
    v_max3_f32 v3, v54, v55, v3
    v_max3_f32 v3, v56, v57, v3
    v_max3_f32 v3, v58, v59, v3
    s_add_u32 s77, s77, 2048
    s_add_u32 s78, s78, 1
    s_cmp_lt_u32 s78, s75
    s_cbranch_scc1 fbl_89
    v_mov_b32 v44, v3
    s_nop 1
    v_permlane32_swap_b32 v44, v3
    s_nop 1
    v_max_f32 v3, v3, v44
    v_mov_b32 v92, 0
    v_mov_b32 v93, 0
    v_mov_b32 v94, 0
    v_mov_b32 v95, 0
    v_mov_b32 v96, 0
    v_mov_b32 v97, 0
    v_mov_b32 v98, 0
    v_mov_b32 v99, 0
    v_mov_b32 v100, 0
    v_mov_b32 v101, 0
    v_mov_b32 v102, 0
    v_mov_b32 v103, 0
    v_mov_b32 v104, 0
    v_mov_b32 v105, 0
    v_mov_b32 v106, 0
    v_mov_b32 v107, 0
    s_mov_b32 s77, s74
    s_mov_b32 s78, 0
fbl_90:
    buffer_load_dwordx4 v[20:23], v6, s[60:63], s77 offen sc1
    s_mov_b64 exec, s[86:87]
    buffer_load_dwordx4 v[28:31], v7, s[60:63], s77 offen offset:1024 sc1
    buffer_load_dwordx4 v[32:35], v7, s[60:63], s77 offen offset:1536 sc1
    s_mov_b64 exec, -1
    s_waitcnt vmcnt(0)
    v_mfma_f32_32x32x16_bf16 v[44:59], v[20:23], v[16:19], 0
    s_nop 15
    v_sub_f32 v44, v44, v3
    v_sub_f32 v45, v45, v3
    v_sub_f32 v46, v46, v3
    v_sub_f32 v47, v47, v3
    v_sub_f32 v48, v48, v3
    v_sub_f32 v49, v49, v3
    v_sub_f32 v50, v50, v3
    v_sub_f32 v51, v51, v3
    v_sub_f32 v52, v52, v3
    v_sub_f32 v53, v53, v3
    v_sub_f32 v54, v54, v3
    v_sub_f32 v55, v55, v3
    v_sub_f32 v56, v56, v3
    v_sub_f32 v57, v57, v3
    v_sub_f32 v58, v58, v3
    v_sub_f32 v59, v59, v3
    v_exp_f32 v44, v44
    v_exp_f32 v45, v45
    v_exp_f32 v46, v46
    v_exp_f32 v47, v47
    v_exp_f32 v48, v48
    v_exp_f32 v49, v49
    v_exp_f32 v50, v50
    v_exp_f32 v51, v51
    v_exp_f32 v52, v52
    v_exp_f32 v53, v53
    v_exp_f32 v54, v54
    v_exp_f32 v55, v55
    v_exp_f32 v56, v56
    v_exp_f32 v57, v57
    v_exp_f32 v58, v58
    v_exp_f32 v59, v59
    s_nop 1
    v_smfmac_f32_32x32x32_bf16 v[92:107], v[28:31], v[44:51], v8
    v_smfmac_f32_32x32x32_bf16 v[92:107], v[32:35], v[52:59], v8
    s_add_u32 s77, s77, 2048
    s_add_u32 s78, s78, 1
    s_cmp_lt_u32 s78, s75
    s_cbranch_scc1 fbl_90
    s_nop 15
    s_branch L_FB_AX_BACK
    s_endpgm
.fill 1200, 4, 0xbf810000
.section .rodata,"a"
.p2align 6
.amdhsa_kernel gated_mix__grouped_kv_mqa__sliding_block__prompt_kernel
  .amdhsa_next_free_vgpr 168
  .amdhsa_next_free_sgpr 102
  .amdhsa_accum_offset 168
  .amdhsa_group_segment_fixed_size 0
  .amdhsa_kernarg_size 96
  .amdhsa_user_sgpr_count 2
  .amdhsa_user_sgpr_kernarg_segment_ptr 1
  .amdhsa_system_sgpr_workgroup_id_x 1
.end_amdhsa_kernel
```
